```python
import torch

def _softmax(x, axis=-1):
    return torch.softmax(x, dim=axis)
def _gelu(x):
    return torch.nn.functional.gelu(x, approximate="tanh")
def _silu(x):
    return torch.nn.functional.silu(x)
def _sigmoid(x):
    return torch.sigmoid(x)
def _layernorm(x, axis=-1, eps=1e-5):
    m = x.mean(dim=axis, keepdim=True)
    v = x.var(dim=axis, keepdim=True, unbiased=False)
    return (x - m) / torch.sqrt(v + eps)
def _scatter_add(tgt, idx, src, axis=0):
    return tgt.clone().index_add_(axis, idx, src)
def _segment_sum(src, seg, n):
    out = torch.zeros((n,) + src.shape[1:], dtype=src.dtype)
    return out.index_add_(0, seg, src)
def _pad(x, pw):
    flat = tuple(v for pair in reversed(pw) for v in pair)
    return torch.nn.functional.pad(x, flat)

kernel_name = 'interleave_layers__spectral_fnet__swiglu_ffn__prompt'

def setup_inputs():

    _w = (lambda a: (lambda t: t.to(torch.bfloat16) if t.is_floating_point() else t)(torch.as_tensor(a)))
    def _A_setup():
        B, S, D = 1, 2048, 512
        ns = torch.arange(S)[:, None] * torch.arange(S)[None, :]
        nd = torch.arange(D)[:, None] * torch.arange(D)[None, :]
        Ws_re = torch.cos(-2.0 * torch.pi * ns / S).to(float)
        Ws_im = torch.sin(-2.0 * torch.pi * ns / S).to(float)
        Wd_re = torch.cos(-2.0 * torch.pi * nd / D).to(float)
        Wd_im = torch.sin(-2.0 * torch.pi * nd / D).to(float)
        return {
            "x": _w((lambda *s: torch.randn(*s, dtype=torch.bfloat16) * 0.05)(B, S, D)),
            "dft_seq_re": _w(Ws_re),
            "dft_seq_im": _w(Ws_im),
            "dft_hid_re": _w(Wd_re),
            "dft_hid_im": _w(Wd_im),
        }
    _A_in = _A_setup()

    def _B_setup():
        B, S, D, F = 1, 2048, 512, 1376
        return {
            "x": _w((lambda *s: torch.randn(*s, dtype=torch.bfloat16) * 0.05)(B, S, D)),
            "w_gate": _w((lambda *s: torch.randn(*s, dtype=torch.bfloat16) * 0.4)(D, F)),
            "w_up": _w((lambda *s: torch.randn(*s, dtype=torch.bfloat16) * 0.4)(D, F)),
            "w_down": _w((lambda *s: torch.randn(*s, dtype=torch.bfloat16) * 0.4)(F, D)),
        }
    _B_in = _B_setup()

    return {
        "A_x": _A_in["x"],
        "A_dft_seq_re": _A_in["dft_seq_re"],
        "A_dft_seq_im": _A_in["dft_seq_im"],
        "A_dft_hid_re": _A_in["dft_hid_re"],
        "A_dft_hid_im": _A_in["dft_hid_im"],
        "B_x": _B_in["x"],
        "B_w_gate": _B_in["w_gate"],
        "B_w_up": _B_in["w_up"],
        "B_w_down": _B_in["w_down"],
    }

def reference(A_x, A_dft_seq_re, A_dft_seq_im, A_dft_hid_re, A_dft_hid_im, B_x, B_w_gate, B_w_up, B_w_down):
    def _A_ref(x, dft_seq_re, dft_seq_im, dft_hid_re, dft_hid_im):
        a = torch.einsum("bsd,ed->bse", x, dft_hid_re)
        b = torch.einsum("bsd,ed->bse", x, dft_hid_im)
        y = torch.einsum("ts,bse->bte", dft_seq_re, a) - torch.einsum("ts,bse->bte", dft_seq_im, b)
        return y

    def _B_ref(x, w_gate, w_up, w_down):
        g = _silu(x @ w_gate)
        u = x @ w_up
        return (g * u) @ w_down

    x = A_x
    x = x + _A_ref(_layernorm(x, axis=-1), A_dft_seq_re, A_dft_seq_im, A_dft_hid_re, A_dft_hid_im)
    x = x + _B_ref(_layernorm(x, axis=-1), B_w_gate, B_w_up, B_w_down)
    x = x + _A_ref(_layernorm(x, axis=-1), A_dft_seq_re, A_dft_seq_im, A_dft_hid_re, A_dft_hid_im)
    x = x + _B_ref(_layernorm(x, axis=-1), B_w_gate, B_w_up, B_w_down)
    return x
```

```asm
; @launch grid=(256,1,1) block=(256,1,1) lds=163840
.amdgcn_target "amdgcn-amd-amdhsa--gfx950"
.text
.globl interleave_layers__spectral_fnet__swiglu_ffn__prompt_kernel
.p2align 8
.type interleave_layers__spectral_fnet__swiglu_ffn__prompt_kernel,@function
interleave_layers__spectral_fnet__swiglu_ffn__prompt_kernel:
    s_cmp_ge_u32 s2, 256
    s_cbranch_scc1 L_end
    s_load_dwordx2 s[30:31], s[0:1], 0
    s_load_dwordx4 s[44:47], s[0:1], 48
    s_load_dwordx4 s[48:51], s[0:1], 64
    s_load_dwordx2 s[52:53], s[0:1], 88
    s_getpc_b64 s[84:85]
L_pc:
    v_lshlrev_b32 v1, 7, v0
    v_add_u32 v2, 32768, v1
    v_cmp_gt_u32 vcc, L_end-L_pc, v2
    v_min_u32 v1, L_end-L_pc, v1
    v_min_u32 v2, L_end-L_pc, v2
    global_load_dword v169, v1, s[84:85]
    s_and_saveexec_b64 s[86:87], vcc
    s_cbranch_execz L_pf2
    global_load_dword v169, v2, s[84:85]
L_pf2:
    s_mov_b64 exec, -1
    s_and_b32 s82, s2, 7
    s_lshr_b32 s83, s2, 3
    s_and_b32 s33, s83, 15
    s_lshr_b32 s83, s83, 4
    s_lshl_b32 s32, s82, 1
    s_add_u32 s32, s32, s83
    s_lshr_b32 s34, s33, 3
    s_and_b32 s35, s33, 7
    s_lshl_b32 s40, s32, 4
    s_add_u32 s40, s40, s33
    s_sub_u32 s82, 32, s32
    s_cmp_eq_u32 s32, 0
    s_cselect_b32 s82, 16, s82
    s_cmp_eq_u32 s34, 0
    s_cselect_b32 s36, s32, s82
    v_lshrrev_b32 v5, 6, v0
    v_and_b32 v0, 63, v0
    v_readfirstlane_b32 s37, v5
    v_and_b32 v2, 15, v0
    v_lshrrev_b32 v3, 4, v0
    v_lshlrev_b32 v1, 4, v0
    s_lshr_b32 s82, s37, 1
    s_lshl_b32 s82, s82, 5
    s_add_u32 s82, s82, s36
    s_and_b32 s83, s37, 1
    s_lshl_b32 s83, s83, 10
    s_add_u32 s82, s82, s83
    s_lshl_b32 s82, s82, 10
    s_lshl_b32 s83, s35, 7
    s_add_u32 s39, s82, s83
    v_lshrrev_b32 v6, 2, v0
    v_and_b32 v7, 3, v0
    v_lshlrev_b32 v4, 16, v6
    v_lshl_add_u32 v4, v7, 4, v4
    v_add_u32 v4, s82, v4
    v_mul_u32_u24 v6, 160, v6
    v_lshl_add_u32 v244, v7, 3, v6
    s_mov_b32 s10, 2097152
    s_mov_b32 s11, 0x20000
    s_waitcnt lgkmcnt(0)
    s_load_dword s42, s[52:53], 0
    s_mov_b32 s8, s30
    s_mov_b32 s9, s31
    s_mov_b32 s81, 0x3f803f80
    buffer_load_dwordx4 v[128:131], v4, s[8:11], s83 offen offset:0
    buffer_load_dwordx4 v[132:135], v4, s[8:11], s83 offen offset:64
    buffer_load_dwordx4 v[96:99], v4, s[8:11], 0 offen offset:0
    buffer_load_dwordx4 v[100:103], v4, s[8:11], 0 offen offset:64
    buffer_load_dwordx4 v[104:107], v4, s[8:11], 0 offen offset:128
    buffer_load_dwordx4 v[108:111], v4, s[8:11], 0 offen offset:192
    buffer_load_dwordx4 v[112:115], v4, s[8:11], 0 offen offset:256
    buffer_load_dwordx4 v[116:119], v4, s[8:11], 0 offen offset:320
    buffer_load_dwordx4 v[120:123], v4, s[8:11], 0 offen offset:384
    buffer_load_dwordx4 v[124:127], v4, s[8:11], 0 offen offset:448
    buffer_load_dwordx4 v[192:195], v4, s[8:11], 0 offen offset:512
    s_mov_b32 s12, s44
    s_mov_b32 s13, s45
    s_mov_b32 s14, 1409024
    s_mov_b32 s15, 0x20000
    s_mov_b32 s96, s46
    s_mov_b32 s97, s47
    s_mov_b32 s98, 1409024
    s_mov_b32 s99, 0x20000
    s_lshl_b32 s82, s32, 5
    s_lshl_b32 s83, s37, 3
    s_add_u32 s82, s82, s83
    v_add_u32 v170, s82, v3
    v_mul_u32_u24 v170, 2752, v170
    s_mul_i32 s83, s33, 11
    v_add_u32 v171, s83, v2
    v_lshl_add_u32 v174, v171, 4, v170
    v_cmp_gt_u32 vcc, 172, v171
    v_cmp_gt_u32 s[84:85], 11, v2
    v_mov_b32 v172, 0x7f000000
    s_and_b64 vcc, vcc, s[84:85]
    v_cndmask_b32 v174, v172, v174, vcc
    v_add_u32 v175, 11008, v174
    s_mov_b32 s4, s52
    s_mov_b32 s5, s53
    s_mov_b32 s6, 268435456
    s_mov_b32 s7, 0x20000
    s_mov_b32 s24, s48
    s_mov_b32 s25, s49
    s_mov_b32 s26, 1409024
    s_mov_b32 s27, 0x20000
    s_lshl_b32 s82, s37, 19
    s_lshl_b32 s83, s36, 11
    s_add_u32 s82, s82, s83
    s_lshl_b32 s83, s35, 8
    s_add_u32 s82, s82, s83
    s_add_u32 s67, s82, 1048576
    s_lshl_b32 s82, s37, 15
    s_lshr_b32 s83, s35, 1
    s_lshl_b32 s83, s83, 13
    s_add_u32 s82, s82, s83
    s_lshl_b32 s83, s36, 1
    s_and_b32 s84, s35, 1
    s_add_u32 s83, s83, s84
    s_lshr_b32 s84, s83, 3
    s_lshl_b32 s84, s84, 7
    s_add_u32 s82, s82, s84
    s_and_b32 s83, s83, 7
    s_lshl_b32 s83, s83, 2
    s_add_u32 s82, s82, s83
    s_add_u32 s68, s82, 32505856
    s_mov_b32 s64, 0x3b000000
    v_lshlrev_b32 v5, 4, v2
    v_lshl_add_u32 v5, v3, 10, v5
    s_mul_i32 s82, s37, 2560
    s_add_u32 s82, s82, 147456
    v_add_u32 v244, s82, v244
    v_lshrrev_b32 v32, 2, v2
    v_lshl_add_u32 v33, v3, 2, v32
    v_and_b32 v34, 3, v2
    v_mul_u32_u24 v7, 160, v33
    v_lshl_add_u32 v7, v34, 3, v7
    v_add_u32 v7, 147456, v7
    v_lshrrev_b32 v8, 1, v2
    v_lshlrev_b32 v8, 16, v8
    v_and_b32 v35, 1, v2
    v_lshl_add_u32 v8, v35, 4, v8
    v_lshl_add_u32 v8, v3, 5, v8
    s_getreg_b32 s3, hwreg(HW_REG_XCC_ID, 0, 4)
    s_waitcnt lgkmcnt(0)
    s_mul_i32 s28, s42, 0x9E3779B1
    s_add_u32 s28, s28, 0x7F4A7C15
    s_mov_b32 s29, s28
    s_add_u32 s3, s3, s28
    v_mov_b32 v30, s28
    v_mov_b32 v236, s3
    s_lshl_b32 s82, s40, 7
    s_add_u32 s38, s82, 98304
    s_lshl_b32 s82, s37, 4
    v_add_u32 v60, s82, v2
    v_lshrrev_b32 v61, 1, v60
    v_cmp_eq_u32 vcc, 1, v60
    v_and_b32 v62, 1, v60
    v_cvt_f32_u32 v63, v3
    v_cndmask_b32 v61, v61, 32, vcc
    v_cndmask_b32 v62, v62, 0, vcc
    v_and_b32 v60, 1, v61
    v_cvt_f32_u32 v61, v61
    v_cvt_f32_u32 v62, v62
    v_mul_f32 v61, 0x3c800000, v61
    v_mul_f32 v62, 0x3e800000, v62
    v_mul_f32 v63, 0x41000000, v63
    v_fma_f32 v62, v61, v63, v62
    v_mul_u32_u24 v60, 0x8000, v60
    v_lshl_or_b32 v60, v60, 16, v60
    v_fmamk_f32 v136, v61, 0x00000000, v62
    v_cos_f32 v136, v136
    v_fmamk_f32 v137, v61, 0x40000000, v62
    v_cos_f32 v137, v137
    s_nop 0
    v_cvt_pk_bf16_f32 v88, v136, v137
    v_xor_b32 v90, v60, v88
    v_fmamk_f32 v136, v61, 0x40800000, v62
    v_cos_f32 v136, v136
    v_fmamk_f32 v137, v61, 0x40c00000, v62
    v_cos_f32 v137, v137
    s_nop 0
    v_cvt_pk_bf16_f32 v89, v136, v137
    v_xor_b32 v91, v60, v89
    v_fmamk_f32 v136, v61, 0x3f800000, v62
    v_cos_f32 v136, v136
    v_fmamk_f32 v137, v61, 0x40400000, v62
    v_cos_f32 v137, v137
    s_nop 0
    v_cvt_pk_bf16_f32 v92, v136, v137
    v_xor_b32 v94, v60, v92
    v_fmamk_f32 v136, v61, 0x40a00000, v62
    v_cos_f32 v136, v136
    v_fmamk_f32 v137, v61, 0x40e00000, v62
    v_cos_f32 v137, v137
    s_nop 0
    v_cvt_pk_bf16_f32 v93, v136, v137
    v_xor_b32 v95, v60, v93
    s_waitcnt vmcnt(9)
    buffer_load_dwordx4 v[196:199], v4, s[8:11], 0 offen offset:576
    v_lshlrev_b32 v64, 16, v128
    v_and_b32 v65, 0xffff0000, v128
    v_lshlrev_b32 v66, 16, v129
    v_and_b32 v67, 0xffff0000, v129
    v_lshlrev_b32 v68, 16, v130
    v_and_b32 v69, 0xffff0000, v130
    v_lshlrev_b32 v70, 16, v131
    v_and_b32 v71, 0xffff0000, v131
    buffer_load_dwordx4 v[200:203], v4, s[8:11], 0 offen offset:640
    v_lshlrev_b32 v72, 16, v132
    v_and_b32 v73, 0xffff0000, v132
    v_lshlrev_b32 v74, 16, v133
    v_and_b32 v75, 0xffff0000, v133
    v_lshlrev_b32 v76, 16, v134
    v_and_b32 v77, 0xffff0000, v134
    v_lshlrev_b32 v78, 16, v135
    v_and_b32 v79, 0xffff0000, v135
    s_waitcnt vmcnt(10)
    buffer_load_dwordx4 v[204:207], v4, s[8:11], 0 offen offset:704
    v_dot2_f32_bf16 v48, v96, s81, 0
    v_dot2_f32_bf16 v49, v96, v96, 0
    v_dot2_f32_bf16 v48, v97, s81, v48
    v_dot2_f32_bf16 v49, v97, v97, v49
    v_dot2_f32_bf16 v48, v98, s81, v48
    v_dot2_f32_bf16 v49, v98, v98, v49
    v_dot2_f32_bf16 v48, v99, s81, v48
    v_dot2_f32_bf16 v49, v99, v99, v49
    s_waitcnt vmcnt(10)
    buffer_load_dwordx4 v[208:211], v4, s[8:11], 0 offen offset:768
    v_dot2_f32_bf16 v48, v100, s81, v48
    v_dot2_f32_bf16 v49, v100, v100, v49
    v_dot2_f32_bf16 v48, v101, s81, v48
    v_dot2_f32_bf16 v49, v101, v101, v49
    v_dot2_f32_bf16 v48, v102, s81, v48
    v_dot2_f32_bf16 v49, v102, v102, v49
    v_dot2_f32_bf16 v48, v103, s81, v48
    v_dot2_f32_bf16 v49, v103, v103, v49
    s_waitcnt vmcnt(10)
    buffer_load_dwordx4 v[212:215], v4, s[8:11], 0 offen offset:832
    v_dot2_f32_bf16 v48, v104, s81, v48
    v_dot2_f32_bf16 v49, v104, v104, v49
    v_dot2_f32_bf16 v48, v105, s81, v48
    v_dot2_f32_bf16 v49, v105, v105, v49
    v_dot2_f32_bf16 v48, v106, s81, v48
    v_dot2_f32_bf16 v49, v106, v106, v49
    v_dot2_f32_bf16 v48, v107, s81, v48
    v_dot2_f32_bf16 v49, v107, v107, v49
    s_waitcnt vmcnt(10)
    buffer_load_dwordx4 v[216:219], v4, s[8:11], 0 offen offset:896
    v_dot2_f32_bf16 v48, v108, s81, v48
    v_dot2_f32_bf16 v49, v108, v108, v49
    v_dot2_f32_bf16 v48, v109, s81, v48
    v_dot2_f32_bf16 v49, v109, v109, v49
    v_dot2_f32_bf16 v48, v110, s81, v48
    v_dot2_f32_bf16 v49, v110, v110, v49
    v_dot2_f32_bf16 v48, v111, s81, v48
    v_dot2_f32_bf16 v49, v111, v111, v49
    s_waitcnt vmcnt(10)
    buffer_load_dwordx4 v[220:223], v4, s[8:11], 0 offen offset:960
    v_dot2_f32_bf16 v48, v112, s81, v48
    v_dot2_f32_bf16 v49, v112, v112, v49
    v_dot2_f32_bf16 v48, v113, s81, v48
    v_dot2_f32_bf16 v49, v113, v113, v49
    v_dot2_f32_bf16 v48, v114, s81, v48
    v_dot2_f32_bf16 v49, v114, v114, v49
    v_dot2_f32_bf16 v48, v115, s81, v48
    v_dot2_f32_bf16 v49, v115, v115, v49
    s_waitcnt vmcnt(10)
    buffer_load_dwordx4 v[144:147], v174, s[12:15], 0 offen
    v_dot2_f32_bf16 v48, v116, s81, v48
    v_dot2_f32_bf16 v49, v116, v116, v49
    v_dot2_f32_bf16 v48, v117, s81, v48
    v_dot2_f32_bf16 v49, v117, v117, v49
    v_dot2_f32_bf16 v48, v118, s81, v48
    v_dot2_f32_bf16 v49, v118, v118, v49
    v_dot2_f32_bf16 v48, v119, s81, v48
    v_dot2_f32_bf16 v49, v119, v119, v49
    s_waitcnt vmcnt(10)
    buffer_load_dwordx4 v[148:151], v174, s[96:99], 0 offen
    v_dot2_f32_bf16 v48, v120, s81, v48
    v_dot2_f32_bf16 v49, v120, v120, v49
    v_dot2_f32_bf16 v48, v121, s81, v48
    v_dot2_f32_bf16 v49, v121, v121, v49
    v_dot2_f32_bf16 v48, v122, s81, v48
    v_dot2_f32_bf16 v49, v122, v122, v49
    v_dot2_f32_bf16 v48, v123, s81, v48
    v_dot2_f32_bf16 v49, v123, v123, v49
    s_waitcnt vmcnt(10)
    buffer_load_dwordx4 v[152:155], v175, s[12:15], 0 offen
    v_dot2_f32_bf16 v48, v124, s81, v48
    v_dot2_f32_bf16 v49, v124, v124, v49
    v_dot2_f32_bf16 v48, v125, s81, v48
    v_dot2_f32_bf16 v49, v125, v125, v49
    v_dot2_f32_bf16 v48, v126, s81, v48
    v_dot2_f32_bf16 v49, v126, v126, v49
    v_dot2_f32_bf16 v48, v127, s81, v48
    v_dot2_f32_bf16 v49, v127, v127, v49
    s_waitcnt vmcnt(10)
    buffer_load_dwordx4 v[156:159], v175, s[96:99], 0 offen
    v_dot2_f32_bf16 v48, v192, s81, v48
    v_dot2_f32_bf16 v49, v192, v192, v49
    v_dot2_f32_bf16 v48, v193, s81, v48
    v_dot2_f32_bf16 v49, v193, v193, v49
    v_dot2_f32_bf16 v48, v194, s81, v48
    v_dot2_f32_bf16 v49, v194, v194, v49
    v_dot2_f32_bf16 v48, v195, s81, v48
    v_dot2_f32_bf16 v49, v195, v195, v49
    s_waitcnt vmcnt(10)
    v_dot2_f32_bf16 v48, v196, s81, v48
    v_dot2_f32_bf16 v49, v196, v196, v49
    v_dot2_f32_bf16 v48, v197, s81, v48
    v_dot2_f32_bf16 v49, v197, v197, v49
    v_dot2_f32_bf16 v48, v198, s81, v48
    v_dot2_f32_bf16 v49, v198, v198, v49
    v_dot2_f32_bf16 v48, v199, s81, v48
    v_dot2_f32_bf16 v49, v199, v199, v49
    s_waitcnt vmcnt(9)
    v_dot2_f32_bf16 v48, v200, s81, v48
    v_dot2_f32_bf16 v49, v200, v200, v49
    v_dot2_f32_bf16 v48, v201, s81, v48
    v_dot2_f32_bf16 v49, v201, v201, v49
    v_dot2_f32_bf16 v48, v202, s81, v48
    v_dot2_f32_bf16 v49, v202, v202, v49
    v_dot2_f32_bf16 v48, v203, s81, v48
    v_dot2_f32_bf16 v49, v203, v203, v49
    s_waitcnt vmcnt(8)
    v_dot2_f32_bf16 v48, v204, s81, v48
    v_dot2_f32_bf16 v49, v204, v204, v49
    v_dot2_f32_bf16 v48, v205, s81, v48
    v_dot2_f32_bf16 v49, v205, v205, v49
    v_dot2_f32_bf16 v48, v206, s81, v48
    v_dot2_f32_bf16 v49, v206, v206, v49
    v_dot2_f32_bf16 v48, v207, s81, v48
    v_dot2_f32_bf16 v49, v207, v207, v49
    s_waitcnt vmcnt(7)
    v_dot2_f32_bf16 v48, v208, s81, v48
    v_dot2_f32_bf16 v49, v208, v208, v49
    v_dot2_f32_bf16 v48, v209, s81, v48
    v_dot2_f32_bf16 v49, v209, v209, v49
    v_dot2_f32_bf16 v48, v210, s81, v48
    v_dot2_f32_bf16 v49, v210, v210, v49
    v_dot2_f32_bf16 v48, v211, s81, v48
    v_dot2_f32_bf16 v49, v211, v211, v49
    s_waitcnt vmcnt(6)
    v_dot2_f32_bf16 v48, v212, s81, v48
    v_dot2_f32_bf16 v49, v212, v212, v49
    v_dot2_f32_bf16 v48, v213, s81, v48
    v_dot2_f32_bf16 v49, v213, v213, v49
    v_dot2_f32_bf16 v48, v214, s81, v48
    v_dot2_f32_bf16 v49, v214, v214, v49
    v_dot2_f32_bf16 v48, v215, s81, v48
    v_dot2_f32_bf16 v49, v215, v215, v49
    s_waitcnt vmcnt(5)
    v_dot2_f32_bf16 v48, v216, s81, v48
    v_dot2_f32_bf16 v49, v216, v216, v49
    v_dot2_f32_bf16 v48, v217, s81, v48
    v_dot2_f32_bf16 v49, v217, v217, v49
    v_dot2_f32_bf16 v48, v218, s81, v48
    v_dot2_f32_bf16 v49, v218, v218, v49
    v_dot2_f32_bf16 v48, v219, s81, v48
    v_dot2_f32_bf16 v49, v219, v219, v49
    s_waitcnt vmcnt(4)
    v_dot2_f32_bf16 v48, v220, s81, v48
    v_dot2_f32_bf16 v49, v220, v220, v49
    v_dot2_f32_bf16 v48, v221, s81, v48
    v_dot2_f32_bf16 v49, v221, v221, v49
    v_dot2_f32_bf16 v48, v222, s81, v48
    v_dot2_f32_bf16 v49, v222, v222, v49
    v_dot2_f32_bf16 v48, v223, s81, v48
    v_dot2_f32_bf16 v49, v223, v223, v49
    s_nop 2
    v_add_f32_dpp v48, v48, v48 quad_perm:[1,0,3,2] row_mask:0xf bank_mask:0xf
    v_add_f32_dpp v49, v49, v49 quad_perm:[1,0,3,2] row_mask:0xf bank_mask:0xf
    s_nop 0
    v_add_f32_dpp v48, v48, v48 quad_perm:[2,3,0,1] row_mask:0xf bank_mask:0xf
    v_add_f32_dpp v49, v49, v49 quad_perm:[2,3,0,1] row_mask:0xf bank_mask:0xf
    v_mul_f32 v48, s64, v48
    v_mul_f32 v61, v48, v48
    v_fma_f32 v49, v49, s64, -v61
    v_max_f32 v49, 0, v49
    v_add_f32 v49, 0x3727c5ac, v49
    v_rsq_f32 v60, v49
    s_nop 0
    v_mul_f32 v61, v48, v60
    v_pk_fma_f32 v[64:65], v[64:65], v[60:61], v[60:61] op_sel:[0,0,1] op_sel_hi:[1,0,1] neg_lo:[0,0,1] neg_hi:[0,0,1]
    v_cvt_pk_bf16_f32 v128, v64, v65
    v_pk_fma_f32 v[66:67], v[66:67], v[60:61], v[60:61] op_sel:[0,0,1] op_sel_hi:[1,0,1] neg_lo:[0,0,1] neg_hi:[0,0,1]
    v_cvt_pk_bf16_f32 v129, v66, v67
    ds_write_b64 v244, v[128:129] offset:0
    v_pk_fma_f32 v[68:69], v[68:69], v[60:61], v[60:61] op_sel:[0,0,1] op_sel_hi:[1,0,1] neg_lo:[0,0,1] neg_hi:[0,0,1]
    v_cvt_pk_bf16_f32 v130, v68, v69
    v_pk_fma_f32 v[70:71], v[70:71], v[60:61], v[60:61] op_sel:[0,0,1] op_sel_hi:[1,0,1] neg_lo:[0,0,1] neg_hi:[0,0,1]
    v_cvt_pk_bf16_f32 v131, v70, v71
    ds_write_b64 v244, v[130:131] offset:32
    v_pk_fma_f32 v[72:73], v[72:73], v[60:61], v[60:61] op_sel:[0,0,1] op_sel_hi:[1,0,1] neg_lo:[0,0,1] neg_hi:[0,0,1]
    v_cvt_pk_bf16_f32 v132, v72, v73
    v_pk_fma_f32 v[74:75], v[74:75], v[60:61], v[60:61] op_sel:[0,0,1] op_sel_hi:[1,0,1] neg_lo:[0,0,1] neg_hi:[0,0,1]
    v_cvt_pk_bf16_f32 v133, v74, v75
    ds_write_b64 v244, v[132:133] offset:64
    v_pk_fma_f32 v[76:77], v[76:77], v[60:61], v[60:61] op_sel:[0,0,1] op_sel_hi:[1,0,1] neg_lo:[0,0,1] neg_hi:[0,0,1]
    v_cvt_pk_bf16_f32 v134, v76, v77
    v_pk_fma_f32 v[78:79], v[78:79], v[60:61], v[60:61] op_sel:[0,0,1] op_sel_hi:[1,0,1] neg_lo:[0,0,1] neg_hi:[0,0,1]
    v_cvt_pk_bf16_f32 v135, v78, v79
    ds_write_b64 v244, v[134:135] offset:96
    s_waitcnt lgkmcnt(0)
    s_barrier
    ds_read_b64_tr_b16 v[96:97], v7 offset:0
    ds_read_b64_tr_b16 v[98:99], v7 offset:2560
    ds_read_b64_tr_b16 v[100:101], v7 offset:5120
    ds_read_b64_tr_b16 v[102:103], v7 offset:7680
    ds_read_b64_tr_b16 v[104:105], v7 offset:32
    ds_read_b64_tr_b16 v[106:107], v7 offset:2592
    ds_read_b64_tr_b16 v[108:109], v7 offset:5152
    ds_read_b64_tr_b16 v[110:111], v7 offset:7712
    ds_read_b64_tr_b16 v[112:113], v7 offset:64
    ds_read_b64_tr_b16 v[114:115], v7 offset:2624
    ds_read_b64_tr_b16 v[116:117], v7 offset:5184
    ds_read_b64_tr_b16 v[118:119], v7 offset:7744
    ds_read_b64_tr_b16 v[120:121], v7 offset:96
    ds_read_b64_tr_b16 v[122:123], v7 offset:2656
    ds_read_b64_tr_b16 v[124:125], v7 offset:5216
    ds_read_b64_tr_b16 v[126:127], v7 offset:7776
    s_waitcnt lgkmcnt(12)
    v_mfma_f32_16x16x32_bf16 v[32:35], v[96:99], v[88:91], 0
    v_mfma_f32_16x16x32_bf16 v[32:35], v[100:103], v[92:95], v[32:35]
    s_waitcnt lgkmcnt(8)
    v_mfma_f32_16x16x32_bf16 v[36:39], v[104:107], v[88:91], 0
    v_mfma_f32_16x16x32_bf16 v[36:39], v[108:111], v[92:95], v[36:39]
    s_waitcnt lgkmcnt(4)
    v_mfma_f32_16x16x32_bf16 v[40:43], v[112:115], v[88:91], 0
    v_mfma_f32_16x16x32_bf16 v[40:43], v[116:119], v[92:95], v[40:43]
    s_waitcnt lgkmcnt(0)
    v_mfma_f32_16x16x32_bf16 v[44:47], v[120:123], v[88:91], 0
    v_mfma_f32_16x16x32_bf16 v[44:47], v[124:127], v[92:95], v[44:47]
    v_cvt_pk_bf16_f32 v128, v32, v33
    v_cvt_pk_bf16_f32 v129, v34, v35
    v_cvt_pk_bf16_f32 v130, v36, v37
    v_cvt_pk_bf16_f32 v131, v38, v39
    buffer_store_dwordx4 v[128:131], v8, s[4:7], s67 offen sc1
    v_cvt_pk_bf16_f32 v132, v40, v41
    v_cvt_pk_bf16_f32 v133, v42, v43
    s_nop 0
    v_cvt_pk_bf16_f32 v134, v44, v45
    v_cvt_pk_bf16_f32 v135, v46, v47
    buffer_store_dwordx4 v[132:135], v8, s[4:7], s67 offen offset:128 sc1
    v_lshrrev_b32 v32, 2, v2
    v_and_b32 v34, 3, v2
    s_lshl_b32 s82, s37, 12
    v_lshlrev_b32 v40, 5, v0
    v_add_u32 v40, s82, v40
    v_lshlrev_b32 v43, 9, v32
    v_lshl_add_u32 v43, v3, 5, v43
    v_lshl_add_u32 v43, v34, 3, v43
    v_add_u32 v43, s82, v43
    s_mul_i32 s54, s33, 180224
    s_add_u32 s54, s54, 15728640
    s_lshl_b32 s84, s37, 8
    s_add_u32 s83, s54, s84
    s_lshl_b32 s85, s32, 12
    s_add_u32 s85, s85, s83
    s_add_u32 s86, s85, 114688
    s_mul_i32 s87, s32, 3072
    s_add_u32 s87, s87, s83
    s_add_u32 s87, s87, 65536
    s_waitcnt vmcnt(4)
    v_swap_b32 v145, v148
    v_swap_b32 v147, v149
    v_swap_b32 v146, v148
    v_swap_b32 v149, v150
    ds_write_b128 v40, v[144:147] offset:0
    ds_write_b128 v40, v[148:151] offset:16
    s_waitcnt vmcnt(2)
    v_swap_b32 v153, v156
    v_swap_b32 v155, v157
    v_swap_b32 v154, v156
    v_swap_b32 v157, v158
    ds_write_b128 v40, v[152:155] offset:2048
    ds_write_b128 v40, v[156:159] offset:2064
    s_waitcnt lgkmcnt(0)
    ds_read_b64_tr_b16 v[144:145], v43 offset:0
    ds_read_b64_tr_b16 v[146:147], v43 offset:2048
    ds_read_b64_tr_b16 v[148:149], v43 offset:128
    ds_read_b64_tr_b16 v[150:151], v43 offset:2176
    ds_read_b64_tr_b16 v[152:153], v43 offset:256
    ds_read_b64_tr_b16 v[154:155], v43 offset:2304
    s_waitcnt lgkmcnt(4)
    buffer_store_dwordx4 v[144:147], v5, s[4:7], s85 offen sc1
    s_waitcnt lgkmcnt(2)
    buffer_store_dwordx4 v[148:151], v5, s[4:7], s86 offen sc1
    s_waitcnt lgkmcnt(0)
    s_mov_b32 exec_hi, 0xffff
    buffer_store_dwordx4 v[152:155], v5, s[4:7], s87 offen sc1
    s_mov_b32 exec_hi, -1
    v_lshrrev_b32 v41, 3, v0
    v_and_b32 v42, 1, v41
    v_lshl_add_u32 v40, v3, 3, v42
    v_and_b32 v42, 7, v0
    v_lshlrev_b32 v42, 4, v42
    v_lshl_add_u32 v40, v40, 10, v42
    v_lshl_add_u32 v41, v41, 10, v42
    s_add_u32 s2, s40, 256
    s_mul_i32 s82, s40, 5958
    s_lshr_b32 s82, s82, 16
    s_mul_i32 s83, s82, 11
    s_sub_u32 s83, s40, s83
    s_lshr_b32 s84, s82, 2
    s_and_b32 s82, s82, 3
    s_mul_i32 s82, s82, 352
    s_lshl_b32 s84, s84, 7
    s_lshr_b32 s85, s83, 1
    s_mul_i32 s85, s85, 88
    s_and_b32 s86, s83, 1
    s_lshl_b32 s86, s86, 5
    s_add_u32 s85, s85, s86
    s_lshl_b32 s86, s37, 1
    s_add_u32 s85, s85, s86
    s_lshl_b32 s86, s83, 2
    s_add_u32 s86, s86, s37
    s_sub_u32 s86, s86, 32
    s_mul_i32 s87, s86, 43
    s_lshr_b32 s87, s87, 7
    s_mul_i32 s87, s87, 64
    s_lshl_b32 s86, s86, 3
    s_add_u32 s86, s86, s87
    s_add_u32 s86, s86, 64
    s_cmp_ge_u32 s83, 8
    s_cselect_b32 s85, s86, s85
    s_cselect_b64 vcc, -1, 0
    s_add_u32 s82, s82, s85
    s_lshl_b32 s82, s82, 10
    s_add_u32 s82, s82, s84
    v_cndmask_b32 v46, v40, v41, vcc
    v_add_u32 v46, s82, v46
    s_mul_i32 s82, s2, 5958
    s_lshr_b32 s82, s82, 16
    s_mul_i32 s83, s82, 11
    s_sub_u32 s83, s2, s83
    s_lshr_b32 s84, s82, 2
    s_and_b32 s82, s82, 3
    s_mul_i32 s82, s82, 352
    s_lshl_b32 s84, s84, 7
    s_lshr_b32 s85, s83, 1
    s_mul_i32 s85, s85, 88
    s_and_b32 s86, s83, 1
    s_lshl_b32 s86, s86, 5
    s_add_u32 s85, s85, s86
    s_lshl_b32 s86, s37, 1
    s_add_u32 s85, s85, s86
    s_lshl_b32 s86, s83, 2
    s_add_u32 s86, s86, s37
    s_sub_u32 s86, s86, 32
    s_mul_i32 s87, s86, 43
    s_lshr_b32 s87, s87, 7
    s_mul_i32 s87, s87, 64
    s_lshl_b32 s86, s86, 3
    s_add_u32 s86, s86, s87
    s_add_u32 s86, s86, 64
    s_cmp_ge_u32 s83, 8
    s_cselect_b32 s85, s86, s85
    s_cselect_b64 vcc, -1, 0
    s_add_u32 s82, s82, s85
    s_lshl_b32 s82, s82, 10
    s_add_u32 s82, s82, s84
    v_cndmask_b32 v47, v40, v41, vcc
    v_add_u32 v47, s82, v47
    s_lshl_b32 s82, s36, 13
    s_lshl_b32 s83, s37, 8
    s_add_u32 s82, s82, s83
    s_add_u32 s66, s82, 131072
    s_lshl_b32 s82, s40, 7
    s_lshl_b32 s83, s37, 4
    s_add_u32 s82, s82, s83
    s_add_u32 s74, s82, 65536
    s_lshl_b32 s82, s35, 10
    s_add_u32 s82, s82, s66
    v_lshlrev_b32 v44, 7, v0
    v_add_u32 v44, s82, v44
    v_mov_b32 v45, s74
    v_cmp_gt_u32 vcc, 2, v0
    s_nop 1
    v_cndmask_b32 v44, v45, v44, vcc
    s_waitcnt vmcnt(3)
    s_mov_b64 exec, 1
    buffer_store_dword v30, off, s[4:7], s68 sc1
    s_mov_b64 exec, -1
    buffer_load_dwordx4 v[176:179], v46, s[24:27], 0 offen
    buffer_load_dwordx4 v[180:183], v47, s[24:27], 0 offen
    s_mov_b64 exec, 7
    buffer_load_dword v168, v44, s[4:7], 0 offen sc1
    s_cmp_eq_u32 s37, 0
    s_cselect_b64 exec, 1, 0
    buffer_store_dword v236, off, s[4:7], s38 offset:16 sc1
    s_mov_b64 exec, -1
    s_lshl_b32 s82, s37, 2
    s_add_u32 s1, s82, s38
    s_mov_b32 s12, s50
    s_mov_b32 s13, s51
    s_mov_b32 s14, 2097152
    s_lshr_b32 s82, s33, 2
    s_and_b32 s82, s82, 1
    s_lshl_b32 s82, s82, 5
    s_add_u32 s43, s36, s82
    s_sub_u32 s82, 64, s43
    s_cmp_le_u32 s43, 31
    s_cselect_b32 s41, s43, s82
    s_and_b32 s41, s41, 31
    s_and_b32 s82, s33, 3
    s_lshl_b32 s82, s82, 9
    s_add_u32 s55, s43, s82
    s_lshr_b32 s82, s41, 3
    s_lshl_b32 s82, s82, 15
    s_lshl_b32 s83, s37, 13
    s_add_u32 s82, s82, s83
    s_add_u32 s69, s82, 32505856
    s_lshl_b32 s82, s41, 16
    s_lshl_b32 s83, s37, 9
    s_add_u32 s82, s82, s83
    s_add_u32 s70, s82, 1048576
    s_lshl_b32 s82, s37, 7
    s_add_u32 s82, s82, s55
    s_lshl_b32 s71, s82, 10
    s_add_u32 s80, s71, 65536
    v_lshrrev_b32 v36, 3, v0
    v_and_b32 v37, 7, v0
    v_and_b32 v38, 1, v3
    v_lshrrev_b32 v9, 3, v0
    v_and_b32 v39, 7, v0
    v_lshlrev_b32 v9, 7, v9
    v_lshl_add_u32 v9, v39, 2, v9
    v_lshlrev_b32 v16, 2, v38
    v_xor_b32 v16, v16, v37
    v_lshlrev_b32 v16, 4, v16
    v_lshl_add_u32 v16, v36, 11, v16
    v_lshrrev_b32 v39, 1, v3
    v_lshl_add_u32 v39, v2, 1, v39
    v_lshl_add_u32 v23, v38, 5, v39
    v_lshlrev_b32 v23, 4, v23
    buffer_load_dwordx4 v[160:163], v23, s[8:11], s71 offen sc1
    buffer_load_dwordx4 v[164:167], v23, s[8:11], s80 offen sc1
    s_cmp_eq_u32 s43, 32
    s_cselect_b32 s84, 0, 1.0
    s_cselect_b32 s85, 1.0, 0
    s_cmp_gt_u32 s43, 32
    s_cselect_b32 s86, -1.0, 1.0
    s_and_b32 s82, s43, 31
    s_cmp_eq_u32 s82, 0
    s_cselect_b32 s86, 0, s86
    v_lshrrev_b32 v32, 1, v2
    v_lshlrev_b32 v32, 6, v32
    v_add_u32 v32, s55, v32
    v_cvt_f32_u32 v32, v32
    v_and_b32 v33, 1, v2
    v_cvt_f32_u32 v39, v33
    v_cvt_f32_u32 v34, v3
    v_cvt_f32_u32 v40, v2
    v_mul_f32 v32, 0x3a000000, v32
    v_mul_f32 v39, 0x3e800000, v39
    v_add_f32 v35, v34, v34
    v_fma_f32 v39, v32, v35, v39
    v_mul_u32_u24 v33, 0x8000, v33
    v_lshl_or_b32 v33, v33, 16, v33
    v_mul_f32 v34, 4.0, v34
    v_fmamk_f32 v35, v32, 0x00000000, v39
    v_cos_f32 v36, v35
    v_sin_f32 v37, v35
    v_mul_f32 v38, s85, v36
    v_mul_f32 v36, s84, v36
    v_fma_f32 v37, v37, s86, v38
    v_cvt_pk_bf16_f32 v192, v36, v37
    v_fmamk_f32 v35, v32, 0x3f800000, v39
    v_cos_f32 v36, v35
    v_sin_f32 v37, v35
    v_mul_f32 v38, s85, v36
    v_mul_f32 v36, s84, v36
    v_fma_f32 v37, v37, s86, v38
    v_cvt_pk_bf16_f32 v193, v36, v37
    v_fmamk_f32 v35, v32, 0x41000000, v39
    v_cos_f32 v36, v35
    v_sin_f32 v37, v35
    v_mul_f32 v38, s85, v36
    v_mul_f32 v36, s84, v36
    v_fma_f32 v37, v37, s86, v38
    v_cvt_pk_bf16_f32 v194, v36, v37
    v_fmamk_f32 v35, v32, 0x41100000, v39
    v_cos_f32 v36, v35
    v_sin_f32 v37, v35
    v_mul_f32 v38, s85, v36
    v_mul_f32 v36, s84, v36
    v_fma_f32 v37, v37, s86, v38
    v_cvt_pk_bf16_f32 v195, v36, v37
    v_fmamk_f32 v35, v32, 0x41800000, v39
    v_cos_f32 v36, v35
    v_sin_f32 v37, v35
    v_mul_f32 v38, s85, v36
    v_mul_f32 v36, s84, v36
    v_fma_f32 v37, v37, s86, v38
    v_cvt_pk_bf16_f32 v196, v36, v37
    v_fmamk_f32 v35, v32, 0x41880000, v39
    v_cos_f32 v36, v35
    v_sin_f32 v37, v35
    v_mul_f32 v38, s85, v36
    v_mul_f32 v36, s84, v36
    v_fma_f32 v37, v37, s86, v38
    v_cvt_pk_bf16_f32 v197, v36, v37
    v_fmamk_f32 v35, v32, 0x41c00000, v39
    v_cos_f32 v36, v35
    v_sin_f32 v37, v35
    v_mul_f32 v38, s85, v36
    v_mul_f32 v36, s84, v36
    v_fma_f32 v37, v37, s86, v38
    v_cvt_pk_bf16_f32 v198, v36, v37
    v_fmamk_f32 v35, v32, 0x41c80000, v39
    v_cos_f32 v36, v35
    v_sin_f32 v37, v35
    v_mul_f32 v38, s85, v36
    v_mul_f32 v36, s84, v36
    v_fma_f32 v37, v37, s86, v38
    v_cvt_pk_bf16_f32 v199, v36, v37
    v_mul_f32 v32, 0x3d800000, v40
    v_mul_f32 v39, v32, v34
    v_fmamk_f32 v35, v32, 0x00000000, v39
    v_cos_f32 v44, v35
    v_sin_f32 v48, v35
    v_fmamk_f32 v35, v32, 0x3f800000, v39
    v_cos_f32 v45, v35
    v_sin_f32 v49, v35
    v_fmamk_f32 v35, v32, 0x40000000, v39
    v_cos_f32 v46, v35
    v_sin_f32 v50, v35
    v_fmamk_f32 v35, v32, 0x40400000, v39
    v_cos_f32 v47, v35
    v_sin_f32 v51, v35
    v_cvt_pk_bf16_f32 v202, v44, v45
    v_cvt_pk_bf16_f32 v203, v46, v47
    v_cvt_pk_bf16_f32 v204, v48, v49
    v_cvt_pk_bf16_f32 v205, v50, v51
    v_xor_b32 v200, 0x80008000, v204
    v_xor_b32 v201, 0x80008000, v205
    v_mul_f32 v32, 0x3b000000, v40
    v_mul_f32 v39, v32, v34
    v_fmamk_f32 v35, v32, 0x00000000, v39
    v_cos_f32 v206, v35
    v_sin_f32 v214, v35
    v_fmamk_f32 v35, v32, 0x3f800000, v39
    v_cos_f32 v207, v35
    v_sin_f32 v215, v35
    v_fmamk_f32 v35, v32, 0x40000000, v39
    v_cos_f32 v208, v35
    v_sin_f32 v216, v35
    v_fmamk_f32 v35, v32, 0x40400000, v39
    v_cos_f32 v209, v35
    v_sin_f32 v217, v35
    v_mul_f32 v32, 0x3b000000, v40
    v_mul_f32 v39, v32, v34
    v_fmamk_f32 v35, v32, 0x41800000, v39
    v_cos_f32 v210, v35
    v_sin_f32 v218, v35
    v_fmamk_f32 v35, v32, 0x41880000, v39
    v_cos_f32 v211, v35
    v_sin_f32 v219, v35
    v_fmamk_f32 v35, v32, 0x41900000, v39
    v_cos_f32 v212, v35
    v_sin_f32 v220, v35
    v_fmamk_f32 v35, v32, 0x41980000, v39
    v_cos_f32 v213, v35
    v_sin_f32 v221, v35
    v_mul_f32 v32, 0x3d000000, v40
    v_mul_f32 v39, v32, v34
    v_fmamk_f32 v35, v32, 0x00000000, v39
    v_cos_f32 v44, v35
    v_sin_f32 v48, v35
    v_fmamk_f32 v35, v32, 0x3f800000, v39
    v_cos_f32 v45, v35
    v_sin_f32 v49, v35
    v_fmamk_f32 v35, v32, 0x40000000, v39
    v_cos_f32 v46, v35
    v_sin_f32 v50, v35
    v_fmamk_f32 v35, v32, 0x40400000, v39
    v_cos_f32 v47, v35
    v_sin_f32 v51, v35
    v_cvt_pk_bf16_f32 v222, v44, v45
    v_cvt_pk_bf16_f32 v223, v46, v47
    v_xor_b32 v224, v33, v222
    v_xor_b32 v225, v33, v223
    v_cvt_pk_bf16_f32 v226, v48, v49
    v_cvt_pk_bf16_f32 v227, v50, v51
    v_xor_b32 v228, v33, v226
    v_xor_b32 v229, v33, v227
    v_xor_b32 v230, 0x80000000, v222
    v_xor_b32 v231, 0x80000000, v223
    v_xor_b32 v232, 0x80000000, v224
    v_xor_b32 v233, 0x80000000, v225
    v_xor_b32 v234, 0x80000000, v226
    v_xor_b32 v235, 0x80000000, v227
    v_xor_b32 v236, 0x80000000, v228
    v_xor_b32 v237, 0x80000000, v229
    s_mov_b32 s90, s70
    s_lshl_b32 s91, s37, 14
    s_add_u32 s91, s91, 81664
    s_mov_b32 m0, s91
    s_lshl_b32 s92, s32, 11
    s_add_u32 s92, s92, 98320
    v_lshlrev_b32 v41, 7, v2
    s_lshl_b32 s93, s33, 7
    s_add_u32 s93, s93, 98304
    v_lshlrev_b32 v184, 11, v2
    v_lshl_add_u32 v184, v3, 2, v184
    s_waitcnt vmcnt(6)
    s_mov_b64 exec, 1
    buffer_store_dword v30, off, s[4:7], s1 sc1
    s_mov_b64 exec, -1
    s_mov_b32 s82, 0
L_pG0:
    buffer_load_dword v36, v9, s[4:7], s69 offen sc1
    s_waitcnt vmcnt(0)
    v_cmp_eq_u32 vcc, s28, v36
    s_nop 0
    s_cmp_eq_u64 vcc, exec
    s_cbranch_scc1 L_pG0_ok
    s_add_u32 s82, s82, 1
    s_cmp_lt_u32 s82, 400000
    s_cbranch_scc1 L_pG0
L_pG0_ok:
    buffer_load_dwordx4 v16, s[4:7], s90 offen offset:0 sc1 lds
    s_add_u32 s90, s90, 15360
    buffer_load_dwordx4 v16, s[4:7], s90 offen offset:1024 sc1 lds
    s_add_u32 s90, s90, 15360
    buffer_load_dwordx4 v16, s[4:7], s90 offen offset:2048 sc1 lds
    s_add_u32 s90, s90, 15360
    s_lshl_b32 s82, s37, 12
    v_add_u32 v42, s82, v1
    v_lshrrev_b32 v44, 2, v2
    v_and_b32 v45, 3, v2
    v_lshlrev_b32 v44, 7, v44
    v_lshl_add_u32 v44, v45, 4, v44
    v_lshrrev_b32 v45, 1, v3
    v_lshl_add_u32 v44, v45, 6, v44
    buffer_load_dwordx4 v16, s[4:7], s90 offen offset:3072 sc1 lds
    s_sub_u32 s90, s90, 45952
    v_and_b32 v45, 1, v3
    v_lshl_add_u32 v44, v45, 3, v44
    v_add_u32 v44, s82, v44
    ds_write_b128 v42, v[176:179]
    ds_write_b128 v42, v[180:183] offset:1024
    s_waitcnt lgkmcnt(0)
    ds_read_b64_tr_b16 v[176:177], v44
    ds_read_b64_tr_b16 v[178:179], v44 offset:512
    s_add_u32 m0, m0, 4096
    s_nop 0
    buffer_load_dwordx4 v16, s[4:7], s90 offen offset:0 sc1 lds
    s_add_u32 s90, s90, 15360
    ds_read_b64_tr_b16 v[180:181], v44 offset:1024
    ds_read_b64_tr_b16 v[182:183], v44 offset:1536
    s_waitcnt lgkmcnt(0)
    v_lshrrev_b32 v32, 2, v2
    v_lshl_add_u32 v33, v3, 2, v32
    v_and_b32 v34, 3, v2
    v_and_b32 v35, 1, v2
    v_lshrrev_b32 v36, 3, v0
    buffer_load_dwordx4 v16, s[4:7], s90 offen offset:1024 sc1 lds
    s_add_u32 s90, s90, 15360
    v_and_b32 v37, 7, v0
    v_and_b32 v38, 1, v3
    s_lshl_b32 s82, s37, 14
    s_add_u32 s82, s82, 81664
    v_lshrrev_b32 v18, 1, v33
    v_lshlrev_b32 v18, 7, v18
    v_lshl_add_u32 v18, v38, 6, v18
    v_and_b32 v39, 1, v33
    buffer_load_dwordx4 v16, s[4:7], s90 offen offset:2048 sc1 lds
    s_add_u32 s90, s90, 15360
    v_lshl_add_u32 v18, v39, 4, v18
    v_lshrrev_b32 v39, 1, v34
    v_lshl_add_u32 v18, v39, 5, v18
    v_lshl_add_u32 v18, v35, 3, v18
    v_add_u32 v18, s82, v18
    v_xor_b32 v17, 64, v18
    v_mul_u32_u24 v19, 1032, v2
    v_lshl_add_u32 v19, v3, 3, v19
    buffer_load_dwordx4 v16, s[4:7], s90 offen offset:3072 sc1 lds
    s_sub_u32 s90, s90, 45952
    s_lshl_b32 s82, s37, 8
    s_and_b32 s83, s37, 1
    s_lshl_b32 s83, s83, 5
    s_add_u32 s82, s82, 147200
    s_add_u32 s84, s82, s83
    s_xor_b32 s83, s83, 32
    s_add_u32 s85, s82, s83
    v_add_u32 v20, s85, v19
    s_add_u32 m0, m0, 4096
    s_nop 0
    buffer_load_dwordx4 v16, s[4:7], s90 offen offset:0 sc1 lds
    s_add_u32 s90, s90, 15360
    v_add_u32 v19, s84, v19
    v_lshrrev_b32 v28, 1, v37
    v_mul_u32_u24 v28, 4128, v28
    v_and_b32 v39, 1, v37
    v_lshl_add_u32 v28, v39, 10, v28
    v_lshl_add_u32 v28, v36, 4, v28
    v_add_u32 v28, s82, v28
    v_xor_b32 v31, 16, v28
    buffer_load_dwordx4 v16, s[4:7], s90 offen offset:1024 sc1 lds
    s_add_u32 s90, s90, 15360
    v_lshlrev_b32 v29, 8, v36
    v_lshl_add_u32 v29, v37, 4, v29
    v_lshlrev_b32 v21, 6, v33
    v_lshl_add_u32 v21, v38, 5, v21
    v_lshl_add_u32 v21, v34, 3, v21
    s_mul_i32 s82, s37, 4128
    s_add_u32 s82, s82, 147200
    v_xor_b32 v22, 32, v21
    buffer_load_dwordx4 v16, s[4:7], s90 offen offset:2048 sc1 lds
    s_add_u32 s90, s90, 15360
    v_add_u32 v21, s82, v21
    v_add_u32 v22, s82, v22
    v_lshrrev_b32 v39, 1, v3
    v_lshl_add_u32 v39, v2, 1, v39
    v_and_b32 v27, 1, v32
    v_xor_b32 v27, v27, v39
    v_lshlrev_b32 v27, 4, v27
    v_lshl_add_u32 v27, v38, 3, v27
    buffer_load_dwordx4 v16, s[4:7], s90 offen offset:3072 sc1 lds
    s_sub_u32 s90, s90, 45952
    v_add_u32 v27, s82, v27
    v_lshrrev_b32 v39, 5, v0
    v_lshlrev_b32 v245, 4, v2
    v_lshl_add_u32 v245, v39, 3, v245
    v_add_u32 v242, s54, v1
    s_lshl_b32 s47, s37, 10
    s_lshl_b32 s82, s40, 9
    s_lshl_b32 s83, s37, 7
    s_add_u32 m0, m0, 4096
    s_nop 0
    buffer_load_dwordx4 v16, s[4:7], s90 offen offset:0 sc1 lds
    s_add_u32 s90, s90, 15360
    s_add_u32 s82, s82, s83
    s_add_u32 s0, s82, 9437184
    s_lshr_b32 s82, s40, 1
    s_lshl_b32 s82, s82, 14
    s_and_b32 s83, s33, 1
    s_lshl_b32 s83, s83, 7
    s_add_u32 s81, s82, s83
    s_lshl_b32 s83, s37, 12
    buffer_load_dwordx4 v16, s[4:7], s90 offen offset:1024 sc1 lds
    s_add_u32 s90, s90, 15360
    s_add_u32 s82, s81, s83
    s_add_u32 s73, s82, 5242880
    s_mul_i32 s82, s32, 360448
    s_add_u32 s82, s82, 20971520
    s_mul_i32 s83, s37, 90112
    s_add_u32 s78, s82, s83
    s_mul_i32 s83, s33, 2816
    s_add_u32 s78, s78, s83
    buffer_load_dwordx4 v16, s[4:7], s90 offen offset:2048 sc1 lds
    s_add_u32 s90, s90, 15360
    s_mul_i32 s83, s34, 180224
    s_add_u32 s82, s82, s83
    s_mul_i32 s83, s37, 11264
    s_add_u32 s79, s82, s83
    buffer_load_dwordx4 v16, s[4:7], s90 offen offset:3072 sc1 lds
    s_barrier
    buffer_load_dword v185, v184, s[4:7], s93 offen sc1
    buffer_load_dword v168, v41, s[4:7], s92 offen sc1
    s_waitcnt vmcnt(14)
    ds_read_b64_tr_b16 v[96:97], v18 offset:0
    ds_read_b64_tr_b16 v[98:99], v18 offset:1024
    ds_read_b64_tr_b16 v[100:101], v18 offset:2048
    ds_read_b64_tr_b16 v[102:103], v18 offset:3072
    ds_read_b64_tr_b16 v[104:105], v17 offset:0
    ds_read_b64_tr_b16 v[106:107], v17 offset:1024
    ds_read_b64_tr_b16 v[108:109], v17 offset:2048
    ds_read_b64_tr_b16 v[110:111], v17 offset:3072
    s_waitcnt lgkmcnt(4)
    v_mfma_f32_16x16x32_bf16 v[32:35], v[96:99], v[192:195], 0
    v_mfma_f32_16x16x32_bf16 v[32:35], v[100:103], v[196:199], v[32:35]
    s_waitcnt lgkmcnt(0)
    v_mfma_f32_16x16x32_bf16 v[36:39], v[104:107], v[192:195], 0
    v_mfma_f32_16x16x32_bf16 v[36:39], v[108:111], v[196:199], v[36:39]
    s_waitcnt vmcnt(10)
    ds_read_b64_tr_b16 v[112:113], v18 offset:4096
    ds_read_b64_tr_b16 v[114:115], v18 offset:5120
    ds_read_b64_tr_b16 v[116:117], v18 offset:6144
    ds_read_b64_tr_b16 v[118:119], v18 offset:7168
    ds_read_b64_tr_b16 v[120:121], v17 offset:4096
    ds_read_b64_tr_b16 v[122:123], v17 offset:5120
    ds_read_b64_tr_b16 v[124:125], v17 offset:6144
    ds_read_b64_tr_b16 v[126:127], v17 offset:7168
    v_cvt_pk_bf16_f32 v64, v32, v33
    v_cvt_pk_bf16_f32 v65, v34, v35
    ds_write_b64 v19, v[64:65] offset:0
    v_cvt_pk_bf16_f32 v66, v36, v37
    v_cvt_pk_bf16_f32 v67, v38, v39
    ds_write_b64 v20, v[66:67] offset:0
    s_waitcnt lgkmcnt(6)
    v_mfma_f32_16x16x32_bf16 v[40:43], v[112:115], v[192:195], 0
    v_mfma_f32_16x16x32_bf16 v[40:43], v[116:119], v[196:199], v[40:43]
    s_waitcnt lgkmcnt(2)
    v_mfma_f32_16x16x32_bf16 v[44:47], v[120:123], v[192:195], 0
    v_mfma_f32_16x16x32_bf16 v[44:47], v[124:127], v[196:199], v[44:47]
    s_waitcnt vmcnt(6)
    ds_read_b64_tr_b16 v[128:129], v18 offset:8192
    ds_read_b64_tr_b16 v[130:131], v18 offset:9216
    ds_read_b64_tr_b16 v[132:133], v18 offset:10240
    ds_read_b64_tr_b16 v[134:135], v18 offset:11264
    ds_read_b64_tr_b16 v[136:137], v17 offset:8192
    ds_read_b64_tr_b16 v[138:139], v17 offset:9216
    ds_read_b64_tr_b16 v[140:141], v17 offset:10240
    ds_read_b64_tr_b16 v[142:143], v17 offset:11264
    v_cvt_pk_bf16_f32 v68, v40, v41
    v_cvt_pk_bf16_f32 v69, v42, v43
    ds_write_b64 v19, v[68:69] offset:64
    v_cvt_pk_bf16_f32 v70, v44, v45
    v_cvt_pk_bf16_f32 v71, v46, v47
    ds_write_b64 v20, v[70:71] offset:64
    s_waitcnt lgkmcnt(6)
    v_mfma_f32_16x16x32_bf16 v[48:51], v[128:131], v[192:195], 0
    v_mfma_f32_16x16x32_bf16 v[48:51], v[132:135], v[196:199], v[48:51]
    s_waitcnt lgkmcnt(2)
    v_mfma_f32_16x16x32_bf16 v[52:55], v[136:139], v[192:195], 0
    v_mfma_f32_16x16x32_bf16 v[52:55], v[140:143], v[196:199], v[52:55]
    s_waitcnt vmcnt(2)
    ds_read_b64_tr_b16 v[144:145], v18 offset:12288
    ds_read_b64_tr_b16 v[146:147], v18 offset:13312
    ds_read_b64_tr_b16 v[148:149], v18 offset:14336
    ds_read_b64_tr_b16 v[150:151], v18 offset:15360
    ds_read_b64_tr_b16 v[152:153], v17 offset:12288
    ds_read_b64_tr_b16 v[154:155], v17 offset:13312
    ds_read_b64_tr_b16 v[156:157], v17 offset:14336
    ds_read_b64_tr_b16 v[158:159], v17 offset:15360
    v_cvt_pk_bf16_f32 v72, v48, v49
    v_cvt_pk_bf16_f32 v73, v50, v51
    ds_write_b64 v19, v[72:73] offset:128
    v_cvt_pk_bf16_f32 v74, v52, v53
    v_cvt_pk_bf16_f32 v75, v54, v55
    ds_write_b64 v20, v[74:75] offset:128
    s_waitcnt lgkmcnt(6)
    v_mfma_f32_16x16x32_bf16 v[56:59], v[144:147], v[192:195], 0
    v_mfma_f32_16x16x32_bf16 v[56:59], v[148:151], v[196:199], v[56:59]
    s_waitcnt lgkmcnt(2)
    v_mfma_f32_16x16x32_bf16 v[60:63], v[152:155], v[192:195], 0
    v_mfma_f32_16x16x32_bf16 v[60:63], v[156:159], v[196:199], v[60:63]
    s_lshl_b32 s82, s40, 12
    s_lshl_b32 s83, s37, 8
    s_add_u32 s82, s82, s83
    s_add_u32 s82, s82, 18874368
    s_add_u32 s83, s82, 1048576
    buffer_store_dwordx4 v[176:179], v5, s[4:7], s82 offen sc1
    s_cmp_lt_u32 s40, 96
    s_cselect_b64 exec, -1, 0
    buffer_store_dwordx4 v[180:183], v5, s[4:7], s83 offen sc1
    s_mov_b64 exec, -1
    v_cvt_pk_bf16_f32 v76, v56, v57
    v_cvt_pk_bf16_f32 v77, v58, v59
    ds_write_b64 v19, v[76:77] offset:192
    v_cvt_pk_bf16_f32 v78, v60, v61
    v_cvt_pk_bf16_f32 v79, v62, v63
    ds_write_b64 v20, v[78:79] offset:192
    s_waitcnt vmcnt(2)
    v_cmp_ne_u32 vcc, s28, v185
    s_cbranch_vccnz L_pW_re
L_pW_ok:
    s_waitcnt lgkmcnt(0)
    s_barrier
    ds_read_b64_tr_b16 v[96:97], v21 offset:0
    ds_read_b64_tr_b16 v[98:99], v21 offset:1032
    ds_read_b64_tr_b16 v[100:101], v22 offset:0
    ds_read_b64_tr_b16 v[102:103], v22 offset:1032
    ds_read_b64_tr_b16 v[104:105], v21 offset:2064
    ds_read_b64_tr_b16 v[106:107], v21 offset:3096
    ds_read_b64_tr_b16 v[108:109], v22 offset:2064
    ds_read_b64_tr_b16 v[110:111], v22 offset:3096
    s_add_u32 s46, s78, 45056
    s_add_u32 s46, s78, 45056
    s_waitcnt lgkmcnt(4)
    v_mfma_f32_16x16x32_bf16 v[32:35], v[96:99], v[202:205], 0
    s_add_u32 m0, s47, 0
    v_mfma_f32_16x16x32_bf16 v[40:43], v[96:99], v[200:203], 0
    buffer_load_dwordx4 v242, s[4:7], m0 offen sc1 lds
    v_mfma_f32_16x16x32_bf16 v[36:39], v[100:103], v[202:205], 0
    v_mfma_f32_16x16x32_bf16 v[44:47], v[100:103], v[200:203], 0
    s_waitcnt lgkmcnt(0)
    v_mfma_f32_16x16x32_bf16 v[48:51], v[104:107], v[202:205], 0
    v_mfma_f32_16x16x32_bf16 v[56:59], v[104:107], v[200:203], 0
    v_mfma_f32_16x16x32_bf16 v[52:55], v[108:111], v[202:205], 0
    v_mfma_f32_16x16x32_bf16 v[60:63], v[108:111], v[200:203], 0
    v_pk_mul_f32 v[64:65], v[40:41], v[214:215]
    v_pk_mul_f32 v[66:67], v[32:33], v[214:215]
    v_pk_fma_f32 v[64:65], v[32:33], v[206:207], v[64:65]
    s_add_u32 m0, s47, 4096
    v_pk_fma_f32 v[66:67], v[40:41], v[206:207], v[66:67] neg_lo:[0,0,1] neg_hi:[0,0,1]
    buffer_load_dwordx4 v242, s[4:7], m0 offen sc1 lds
    v_cvt_pk_bf16_f32 v112, v64, v65
    v_cvt_pk_bf16_f32 v116, v66, v67
    v_pk_mul_f32 v[64:65], v[42:43], v[216:217]
    v_pk_mul_f32 v[66:67], v[34:35], v[216:217]
    v_pk_fma_f32 v[64:65], v[34:35], v[208:209], v[64:65]
    v_pk_fma_f32 v[66:67], v[42:43], v[208:209], v[66:67] neg_lo:[0,0,1] neg_hi:[0,0,1]
    v_cvt_pk_bf16_f32 v113, v64, v65
    v_cvt_pk_bf16_f32 v117, v66, v67
    v_pk_mul_f32 v[64:65], v[44:45], v[218:219]
    v_pk_mul_f32 v[66:67], v[36:37], v[218:219]
    s_add_u32 m0, s47, 8192
    v_pk_fma_f32 v[64:65], v[36:37], v[210:211], v[64:65]
    buffer_load_dwordx4 v242, s[4:7], m0 offen sc1 lds
    v_pk_fma_f32 v[66:67], v[44:45], v[210:211], v[66:67] neg_lo:[0,0,1] neg_hi:[0,0,1]
    v_cvt_pk_bf16_f32 v114, v64, v65
    v_cvt_pk_bf16_f32 v118, v66, v67
    v_pk_mul_f32 v[64:65], v[46:47], v[220:221]
    v_pk_mul_f32 v[66:67], v[38:39], v[220:221]
    v_pk_fma_f32 v[64:65], v[38:39], v[212:213], v[64:65]
    v_pk_fma_f32 v[66:67], v[46:47], v[212:213], v[66:67] neg_lo:[0,0,1] neg_hi:[0,0,1]
    v_cvt_pk_bf16_f32 v115, v64, v65
    v_cvt_pk_bf16_f32 v119, v66, v67
    s_nop 0
    v_mfma_f32_16x16x32_bf16 v[80:83], v[112:115], v[222:225], 0
    s_add_u32 m0, s47, 12288
    v_mfma_f32_16x16x32_bf16 v[84:87], v[112:115], v[230:233], 0
    buffer_load_dwordx4 v242, s[4:7], m0 offen sc1 lds
    v_mfma_f32_16x16x32_bf16 v[80:83], v[116:119], v[226:229], v[80:83]
    v_mfma_f32_16x16x32_bf16 v[84:87], v[116:119], v[234:237], v[84:87]
    v_pk_mul_f32 v[64:65], v[56:57], v[214:215]
    v_pk_mul_f32 v[66:67], v[48:49], v[214:215]
    v_pk_fma_f32 v[64:65], v[48:49], v[206:207], v[64:65]
    v_pk_fma_f32 v[66:67], v[56:57], v[206:207], v[66:67] neg_lo:[0,0,1] neg_hi:[0,0,1]
    v_cvt_pk_bf16_f32 v120, v64, v65
    v_cvt_pk_bf16_f32 v124, v66, v67
    v_pk_mul_f32 v[64:65], v[58:59], v[216:217]
    v_pk_mul_f32 v[66:67], v[50:51], v[216:217]
    s_add_u32 m0, s47, 16384
    v_pk_fma_f32 v[64:65], v[50:51], v[208:209], v[64:65]
    buffer_load_dwordx4 v242, s[4:7], m0 offen sc1 lds
    v_pk_fma_f32 v[66:67], v[58:59], v[208:209], v[66:67] neg_lo:[0,0,1] neg_hi:[0,0,1]
    v_cvt_pk_bf16_f32 v121, v64, v65
    v_cvt_pk_bf16_f32 v125, v66, v67
    v_pk_mul_f32 v[64:65], v[60:61], v[218:219]
    v_pk_mul_f32 v[66:67], v[52:53], v[218:219]
    v_pk_fma_f32 v[64:65], v[52:53], v[210:211], v[64:65]
    v_pk_fma_f32 v[66:67], v[60:61], v[210:211], v[66:67] neg_lo:[0,0,1] neg_hi:[0,0,1]
    v_cvt_pk_bf16_f32 v122, v64, v65
    v_cvt_pk_bf16_f32 v126, v66, v67
    v_pk_mul_f32 v[64:65], v[62:63], v[220:221]
    s_add_u32 m0, s47, 20480
    v_pk_mul_f32 v[66:67], v[54:55], v[220:221]
    buffer_load_dwordx4 v242, s[4:7], m0 offen sc1 lds
    v_pk_fma_f32 v[64:65], v[54:55], v[212:213], v[64:65]
    v_pk_fma_f32 v[66:67], v[62:63], v[212:213], v[66:67] neg_lo:[0,0,1] neg_hi:[0,0,1]
    v_cvt_pk_bf16_f32 v123, v64, v65
    v_cvt_pk_bf16_f32 v127, v66, v67
    s_nop 0
    v_mfma_f32_16x16x32_bf16 v[88:91], v[120:123], v[222:225], 0
    v_mfma_f32_16x16x32_bf16 v[92:95], v[120:123], v[230:233], 0
    v_mfma_f32_16x16x32_bf16 v[88:91], v[124:127], v[226:229], v[88:91]
    v_mfma_f32_16x16x32_bf16 v[92:95], v[124:127], v[234:237], v[92:95]
    s_waitcnt vmcnt(7)
    v_permlane16_swap_b32 v160, v162
    s_add_u32 m0, s47, 24576
    v_permlane16_swap_b32 v161, v163
    buffer_load_dwordx4 v242, s[4:7], m0 offen sc1 lds
    v_permlane16_swap_b32 v164, v166
    v_permlane16_swap_b32 v165, v167
    v_lshlrev_b32 v128, 16, v160
    v_and_b32 v129, 0xffff0000, v160
    v_lshlrev_b32 v130, 16, v161
    v_and_b32 v131, 0xffff0000, v161
    v_lshlrev_b32 v132, 16, v162
    v_and_b32 v133, 0xffff0000, v162
    v_lshlrev_b32 v134, 16, v163
    v_and_b32 v135, 0xffff0000, v163
    s_add_u32 m0, s47, 28672
    v_lshlrev_b32 v136, 16, v164
    buffer_load_dwordx4 v242, s[4:7], m0 offen sc1 lds
    v_and_b32 v137, 0xffff0000, v164
    v_lshlrev_b32 v138, 16, v165
    v_and_b32 v139, 0xffff0000, v165
    v_lshlrev_b32 v140, 16, v166
    v_and_b32 v141, 0xffff0000, v166
    v_lshlrev_b32 v142, 16, v167
    v_and_b32 v143, 0xffff0000, v167
    v_cmp_ne_u32 vcc, s3, v168
    s_nop 0
    s_cmp_eq_u64 vcc, 0
    s_cselect_b64 s[60:61], 1, 0
    s_cselect_b64 s[62:63], 0, 1
    s_cselect_b32 s56, 0xffff, 0
    s_cselect_b32 s57, 0xffff, 0
    s_cselect_b32 s58, 0, 0xffff
    s_cselect_b32 s59, 0, 0xffff
    v_pk_add_f32 v[80:81], v[80:81], v[128:129]
    v_pk_add_f32 v[82:83], v[82:83], v[130:131]
    v_pk_add_f32 v[84:85], v[84:85], v[132:133]
    v_pk_add_f32 v[86:87], v[86:87], v[134:135]
    v_pk_add_f32 v[32:33], v[80:81], v[82:83]
    v_pk_mul_f32 v[34:35], v[80:81], v[80:81]
    s_add_u32 m0, s47, 32768
    v_pk_fma_f32 v[34:35], v[82:83], v[82:83], v[34:35]
    buffer_load_dwordx4 v242, s[4:7], m0 offen sc1 lds
    v_pk_add_f32 v[32:33], v[32:33], v[84:85]
    v_pk_fma_f32 v[34:35], v[84:85], v[84:85], v[34:35]
    v_pk_add_f32 v[32:33], v[32:33], v[86:87]
    v_pk_fma_f32 v[34:35], v[86:87], v[86:87], v[34:35]
    v_add_f32 v40, v32, v33
    v_add_f32 v41, v34, v35
    v_pk_add_f32 v[88:89], v[88:89], v[136:137]
    v_pk_add_f32 v[90:91], v[90:91], v[138:139]
    v_pk_add_f32 v[92:93], v[92:93], v[140:141]
    v_pk_add_f32 v[94:95], v[94:95], v[142:143]
    s_add_u32 m0, s47, 36864
    v_pk_add_f32 v[36:37], v[88:89], v[90:91]
    buffer_load_dwordx4 v242, s[4:7], m0 offen sc1 lds
    v_pk_mul_f32 v[38:39], v[88:89], v[88:89]
    v_pk_fma_f32 v[38:39], v[90:91], v[90:91], v[38:39]
    v_pk_add_f32 v[36:37], v[36:37], v[92:93]
    v_pk_fma_f32 v[38:39], v[92:93], v[92:93], v[38:39]
    v_pk_add_f32 v[36:37], v[36:37], v[94:95]
    v_pk_fma_f32 v[38:39], v[94:95], v[94:95], v[38:39]
    v_add_f32 v42, v36, v37
    v_add_f32 v43, v38, v39
    s_nop 0
    v_permlane32_swap_b32 v40, v42
    v_permlane32_swap_b32 v41, v43
    s_add_u32 m0, s47, 40960
    v_add_f32 v40, v40, v42
    buffer_load_dwordx4 v242, s[4:7], m0 offen sc1 lds
    v_add_f32 v41, v41, v43
    s_add_u32 m0, s47, 45056
    s_nop 0
    buffer_load_dwordx4 v242, s[4:7], m0 offen sc1 lds
    v_permlane16_swap_b32 v40, v41
    v_add_f32 v40, v40, v41
    s_nop 1
    v_add_f32_dpp v40, v40, v40 row_ror:8 row_mask:0xf bank_mask:0xf
    s_add_u32 m0, s47, 49152
    s_nop 0
    buffer_load_dwordx4 v242, s[4:7], m0 offen sc1 lds
    v_add_f32_dpp v40, v40, v40 row_ror:4 row_mask:0xf bank_mask:0xf
    s_nop 1
    v_add_f32_dpp v40, v40, v40 row_ror:2 row_mask:0xf bank_mask:0xf
    s_add_u32 m0, s47, 53248
    s_nop 0
    buffer_load_dwordx4 v242, s[4:7], m0 offen sc1 lds
    v_add_f32_dpp v40, v40, v40 row_ror:1 row_mask:0xf bank_mask:0xf
    v_mov_b32 v41, v40
    s_nop 1
    v_permlane16_swap_b32 v40, v41
    v_mul_f32 v40, s64, v40
    v_mul_f32 v45, v40, v40
    v_fma_f32 v41, v41, s64, -v45
    v_max_f32 v41, 0, v41
    v_add_f32 v41, 0x3727c5ac, v41
    v_rsq_f32 v44, v41
    s_nop 0
    v_mul_f32 v44, 0x3fb8aa3b, v44
    v_mul_f32 v45, v40, v44
    v_mov_b32 v48, v44
    v_mov_b32 v49, v45
    v_rcp_f32 v46, v44
    v_permlane32_swap_b32 v44, v48
    v_permlane32_swap_b32 v45, v49
    v_mov_b32 v47, v40
    v_pk_fma_f32 v[80:81], v[80:81], v[44:45], v[44:45] op_sel:[0,0,1] op_sel_hi:[1,0,1] neg_lo:[0,0,1] neg_hi:[0,0,1]
    v_cvt_pk_bf16_f32 v64, v80, v81
    v_pk_fma_f32 v[82:83], v[82:83], v[44:45], v[44:45] op_sel:[0,0,1] op_sel_hi:[1,0,1] neg_lo:[0,0,1] neg_hi:[0,0,1]
    v_cvt_pk_bf16_f32 v65, v82, v83
    ds_write_b64 v27, v[64:65] offset:0
    v_pk_fma_f32 v[84:85], v[84:85], v[44:45], v[44:45] op_sel:[0,0,1] op_sel_hi:[1,0,1] neg_lo:[0,0,1] neg_hi:[0,0,1]
    v_cvt_pk_bf16_f32 v66, v84, v85
    v_pk_fma_f32 v[86:87], v[86:87], v[44:45], v[44:45] op_sel:[0,0,1] op_sel_hi:[1,0,1] neg_lo:[0,0,1] neg_hi:[0,0,1]
    v_cvt_pk_bf16_f32 v67, v86, v87
    ds_write_b64 v27, v[66:67] offset:512
    v_pk_fma_f32 v[88:89], v[88:89], v[48:49], v[48:49] op_sel:[0,0,1] op_sel_hi:[1,0,1] neg_lo:[0,0,1] neg_hi:[0,0,1]
    v_cvt_pk_bf16_f32 v68, v88, v89
    v_pk_fma_f32 v[90:91], v[90:91], v[48:49], v[48:49] op_sel:[0,0,1] op_sel_hi:[1,0,1] neg_lo:[0,0,1] neg_hi:[0,0,1]
    v_cvt_pk_bf16_f32 v69, v90, v91
    ds_write_b64 v27, v[68:69] offset:1024
    v_pk_fma_f32 v[92:93], v[92:93], v[48:49], v[48:49] op_sel:[0,0,1] op_sel_hi:[1,0,1] neg_lo:[0,0,1] neg_hi:[0,0,1]
    v_cvt_pk_bf16_f32 v70, v92, v93
    v_pk_fma_f32 v[94:95], v[94:95], v[48:49], v[48:49] op_sel:[0,0,1] op_sel_hi:[1,0,1] neg_lo:[0,0,1] neg_hi:[0,0,1]
    v_cvt_pk_bf16_f32 v71, v94, v95
    ds_write_b64 v27, v[70:71] offset:1536
    s_waitcnt vmcnt(14)
    s_add_u32 s1, s1, 32
    s_mov_b64 exec, 1
    buffer_store_dword v30, off, s[4:7], s1 sc1
    s_mov_b64 exec, -1
    s_mov_b32 exec_lo, 1
    s_mov_b32 exec_hi, 1
    buffer_store_dwordx2 v[46:47], v245, s[4:7], s0 offen sc1
    s_mov_b64 exec, -1
    s_waitcnt lgkmcnt(0)
    s_barrier
    ds_read_b128 v[48:51], v28
    ds_read_b128 v[52:55], v31 offset:128
    s_waitcnt lgkmcnt(1)
    buffer_store_dwordx4 v[48:51], v29, s[4:7], s73 offen sc1
    s_waitcnt lgkmcnt(0)
    buffer_store_dwordx4 v[52:55], v29, s[4:7], s73 offen offset:2048 sc1
    s_lshl_b32 s82, s32, 3
    s_lshl_b32 s83, s34, 2
    s_add_u32 s82, s82, s83
    s_add_u32 s82, s82, s37
    s_lshl_b32 s84, s82, 10
    s_add_u32 s77, s84, 9437184
    s_lshl_b32 s82, s82, 14
    s_lshl_b32 s83, s35, 11
    s_add_u32 s82, s82, s83
    s_add_u32 s72, s82, 5242880
    s_lshl_b32 s82, s32, 11
    s_lshl_b32 s83, s37, 9
    s_add_u32 s82, s82, s83
    s_add_u32 s76, s82, 65536
    s_lshl_b32 s82, s32, 17
    s_lshl_b32 s83, s37, 15
    s_add_u32 s82, s82, s83
    s_add_u32 s75, s82, 5242880
    s_mov_b32 s65, 0x40053526
    s_mov_b32 s30, s65
    s_mov_b32 s31, s65
    v_and_b32 v34, 3, v2
    v_and_b32 v35, 1, v2
    v_lshlrev_b32 v238, 7, v3
    v_lshl_add_u32 v239, v35, 4, v238
    s_lshl_b32 s82, s34, 5
    v_add_u32 v239, s82, v239
    v_lshl_add_u32 v238, v34, 4, v238
    v_add_u32 v10, 65536, v1
    v_add_u32 v11, 114688, v1
    v_add_u32 v243, 81920, v242
    v_lshrrev_b32 v241, 1, v2
    v_lshlrev_b32 v241, 7, v241
    v_lshl_add_u32 v241, v35, 3, v241
    s_mov_b32 s44, s75
    s_add_u32 s45, s75, 16384
    s_add_u32 s82, s37, 1
    s_and_b32 s82, s82, 3
    s_mul_i32 s82, s82, 45056
    s_add_u32 s96, s79, s82
    s_add_u32 s82, s37, 2
    s_and_b32 s82, s82, 3
    s_mul_i32 s82, s82, 45056
    s_add_u32 s97, s79, s82
    s_add_u32 s82, s37, 3
    s_and_b32 s82, s82, 3
    s_mul_i32 s82, s82, 45056
    s_add_u32 s98, s79, s82
    s_add_u32 s82, s37, 4
    s_and_b32 s82, s82, 3
    s_mul_i32 s82, s82, 45056
    s_add_u32 s99, s79, s82
    s_lshl_b32 s82, s35, 2
    s_add_u32 s82, s82, s37
    s_mul_i32 s82, s82, 11
    v_min_u32 v196, 10, v2
    v_add_u32 v196, s82, v196
    v_and_b32 v196, 255, v196
    v_lshlrev_b32 v196, 7, v196
    v_lshl_add_u32 v196, v3, 2, v196
    s_mov_b32 s2, 98336
    s_lshl_b32 s82, s32, 1
    s_add_u32 s82, s82, s34
    s_add_u32 s82, s82, s35
    s_and_b32 s42, s82, 0
    s_mul_i32 s83, s42, 2816
    s_add_u32 s96, s96, s83
    s_add_u32 s97, s97, s83
    s_add_u32 s98, s98, s83
    s_add_u32 s99, s99, s83
    s_add_u32 s82, s42, 1
    s_cmp_eq_u32 s82, 4
    s_cselect_b32 s82, -3, 1
    s_mul_i32 s84, s82, 2816
    s_add_u32 s82, s42, 2
    s_cmp_eq_u32 s82, 4
    s_cselect_b32 s82, -3, 1
    s_mul_i32 s85, s82, 2816
    s_add_u32 s82, s42, 3
    s_cmp_eq_u32 s82, 4
    s_cselect_b32 s82, -3, 1
    s_mul_i32 s86, s82, 2816
    s_add_u32 s82, s42, 3
    s_and_b32 s82, s82, 3
    s_mul_i32 s87, s82, 2816
    s_mov_b32 s88, s83
    s_waitcnt vmcnt(0)
    s_mov_b64 exec, s[60:61]
    buffer_store_dword v30, off, s[4:7], s74 offset:0
    s_mov_b64 exec, s[62:63]
    buffer_store_dword v30, off, s[4:7], s74 offset:0 sc1
    s_mov_b64 exec, -1
    s_add_u32 m0, s47, 57344
    s_nop 0
    buffer_load_dwordx4 v242, s[4:7], m0 offen sc1 lds
    s_add_u32 m0, s47, 61440
    s_nop 0
    buffer_load_dwordx4 v242, s[4:7], m0 offen sc1 lds
    s_add_u32 m0, s47, 65536
    s_nop 0
    buffer_load_dwordx4 v242, s[4:7], m0 offen sc1 lds
    s_add_u32 m0, s47, 69632
    s_nop 0
    buffer_load_dwordx4 v242, s[4:7], m0 offen sc1 lds
    s_add_u32 m0, s47, 73728
    s_nop 0
    buffer_load_dwordx4 v242, s[4:7], m0 offen sc1 lds
    s_add_u32 m0, s47, 77824
    s_nop 0
    buffer_load_dwordx4 v242, s[4:7], m0 offen sc1 lds
    s_add_u32 m0, s47, 81920
    s_nop 0
    buffer_load_dwordx4 v242, s[4:7], m0 offen sc1 lds
    s_add_u32 m0, s47, 86016
    s_nop 0
    buffer_load_dwordx4 v242, s[4:7], m0 offen sc1 lds
    s_add_u32 m0, s47, 90112
    s_nop 0
    buffer_load_dwordx4 v242, s[4:7], m0 offen sc1 lds
    s_add_u32 m0, s47, 94208
    s_nop 0
    buffer_load_dwordx4 v242, s[4:7], m0 offen sc1 lds
    s_add_u32 m0, s47, 98304
    s_nop 0
    buffer_load_dwordx4 v242, s[4:7], m0 offen sc1 lds
    s_add_u32 m0, s47, 102400
    s_nop 0
    buffer_load_dwordx4 v242, s[4:7], m0 offen sc1 lds
    buffer_load_dword v240, v238, s[4:7], s76 offen offset:0 sc1
    s_waitcnt vmcnt(0)
    v_cmp_ne_u32 vcc, s28, v240
    s_cbranch_vccnz L_pC10_re
L_pC10_ok:
    buffer_load_dwordx4 a[176:179], v1, s[4:7], s44 offen offset:0 sc1
    buffer_load_dwordx4 a[180:183], v1, s[4:7], s45 offen offset:0 sc1
    buffer_load_dwordx4 a[184:187], v1, s[4:7], s44 offen offset:1024 sc1
    buffer_load_dwordx4 a[188:191], v1, s[4:7], s45 offen offset:1024 sc1
    buffer_load_dwordx4 a[192:195], v1, s[4:7], s44 offen offset:2048 sc1
    buffer_load_dwordx4 a[196:199], v1, s[4:7], s45 offen offset:2048 sc1
    buffer_load_dwordx4 a[200:203], v1, s[4:7], s44 offen offset:3072 sc1
    buffer_load_dwordx4 a[204:207], v1, s[4:7], s45 offen offset:3072 sc1
    s_add_u32 s44, s44, 4096
    buffer_load_dwordx4 a[208:211], v1, s[4:7], s44 offen offset:0 sc1
    s_add_u32 s45, s45, 4096
    buffer_load_dwordx4 a[212:215], v1, s[4:7], s45 offen offset:0 sc1
    s_add_u32 s82, s37, 1
    s_and_b32 s82, s82, 3
    s_mul_i32 s82, s82, 12288
    s_add_u32 s82, s82, 98304
    v_add_u32 v12, s82, v1
    s_add_u32 s82, s37, 2
    s_and_b32 s82, s82, 3
    s_mul_i32 s82, s82, 12288
    s_add_u32 s82, s82, 102400
    v_add_u32 v13, s82, v1
    s_add_u32 s82, s37, 3
    s_and_b32 s82, s82, 3
    s_mul_i32 s82, s82, 12288
    s_add_u32 s82, s82, 106496
    v_add_u32 v14, s82, v1
    s_mul_i32 s82, s37, 12288
    s_add_u32 s82, s82, 98304
    v_add_u32 v15, s82, v1
    s_mul_i32 s82, s37, 2560
    s_add_u32 s82, s82, 147456
    v_mul_u32_u24 v6, 160, v2
    v_lshl_add_u32 v6, v3, 3, v6
    v_add_u32 v6, s82, v6
    v_lshlrev_b32 v4, 16, v2
    v_lshl_add_u32 v4, v3, 4, v4
    v_add_u32 v4, s39, v4
    v_add_u32 v36, 0, v3
    v_mul_u32_u24 v37, 43, v36
    v_lshrrev_b32 v37, 7, v37
    v_mul_u32_u24 v38, 3, v37
    v_sub_u32 v36, v36, v38
    v_mul_u32_u24 v37, 2816, v37
    v_lshl_add_u32 v37, v36, 8, v37
    v_lshl_add_u32 v24, v2, 4, v37
    v_add_u32 v36, 4, v3
    v_mul_u32_u24 v37, 43, v36
    v_lshrrev_b32 v37, 7, v37
    v_mul_u32_u24 v38, 3, v37
    v_sub_u32 v36, v36, v38
    v_mul_u32_u24 v37, 2816, v37
    v_lshl_add_u32 v37, v36, 8, v37
    v_lshl_add_u32 v25, v2, 4, v37
    v_add_u32 v36, 8, v3
    v_mul_u32_u24 v37, 43, v36
    v_lshrrev_b32 v37, 7, v37
    v_mul_u32_u24 v38, 3, v37
    v_sub_u32 v36, v36, v38
    v_mul_u32_u24 v37, 2816, v37
    v_lshl_add_u32 v37, v36, 8, v37
    v_lshl_add_u32 v26, v2, 4, v37
    s_lshl_b32 s49, s35, 2
    s_add_u32 s49, s49, s37
    s_mul_i32 s49, s49, 45056
    s_add_u32 s49, s49, 18874368
    s_barrier
    ds_read_b128 v[96:99], v1 offset:0
    ds_read_b128 v[100:103], v1 offset:1024
    ds_read_b128 v[104:107], v1 offset:2048
    ds_read_b128 v[108:111], v1 offset:3072
    ds_read_b128 v[112:115], v1 offset:4096
    ds_read_b128 v[116:119], v1 offset:5120
    s_waitcnt vmcnt(8) lgkmcnt(5)
    v_mfma_f32_16x16x32_bf16 v[32:35], v[96:99], a[176:179], 0
    ds_read_b128 v[120:123], v1 offset:6144
    v_mfma_f32_16x16x32_bf16 v[36:39], v[96:99], a[180:183], 0
    s_waitcnt lgkmcnt(5)
    buffer_load_dwordx4 a[216:219], v1, s[4:7], s44 offen offset:1024 sc1
    v_mfma_f32_16x16x32_bf16 v[40:43], v[100:103], a[176:179], 0
    ds_read_b128 v[124:127], v1 offset:7168
    v_mfma_f32_16x16x32_bf16 v[44:47], v[100:103], a[180:183], 0
    s_waitcnt lgkmcnt(5)
    v_mfma_f32_16x16x32_bf16 v[48:51], v[104:107], a[176:179], 0
    ds_read_b128 v[96:99], v1 offset:8192
    v_mfma_f32_16x16x32_bf16 v[52:55], v[104:107], a[180:183], 0
    s_waitcnt lgkmcnt(5)
    buffer_load_dwordx4 a[220:223], v1, s[4:7], s45 offen offset:1024 sc1
    v_mfma_f32_16x16x32_bf16 v[56:59], v[108:111], a[176:179], 0
    ds_read_b128 v[100:103], v1 offset:9216
    v_mfma_f32_16x16x32_bf16 v[60:63], v[108:111], a[180:183], 0
    s_waitcnt vmcnt(8) lgkmcnt(5)
    v_mfma_f32_16x16x32_bf16 v[32:35], v[112:115], a[184:187], v[32:35]
    ds_read_b128 v[104:107], v1 offset:10240
    v_mfma_f32_16x16x32_bf16 v[36:39], v[112:115], a[188:191], v[36:39]
    s_waitcnt lgkmcnt(5)
    buffer_load_dwordx4 a[224:227], v1, s[4:7], s44 offen offset:2048 sc1
    v_mfma_f32_16x16x32_bf16 v[40:43], v[116:119], a[184:187], v[40:43]
    ds_read_b128 v[108:111], v1 offset:11264
    v_mfma_f32_16x16x32_bf16 v[44:47], v[116:119], a[188:191], v[44:47]
    s_waitcnt lgkmcnt(5)
    v_mfma_f32_16x16x32_bf16 v[48:51], v[120:123], a[184:187], v[48:51]
    ds_read_b128 v[112:115], v1 offset:12288
    v_mfma_f32_16x16x32_bf16 v[52:55], v[120:123], a[188:191], v[52:55]
    s_waitcnt lgkmcnt(5)
    buffer_load_dwordx4 a[228:231], v1, s[4:7], s45 offen offset:2048 sc1
    v_mfma_f32_16x16x32_bf16 v[56:59], v[124:127], a[184:187], v[56:59]
    ds_read_b128 v[116:119], v1 offset:13312
    v_mfma_f32_16x16x32_bf16 v[60:63], v[124:127], a[188:191], v[60:63]
    s_waitcnt vmcnt(8) lgkmcnt(5)
    v_mfma_f32_16x16x32_bf16 v[32:35], v[96:99], a[192:195], v[32:35]
    ds_read_b128 v[120:123], v1 offset:14336
    v_mfma_f32_16x16x32_bf16 v[36:39], v[96:99], a[196:199], v[36:39]
    s_waitcnt lgkmcnt(5)
    buffer_load_dwordx4 a[232:235], v1, s[4:7], s44 offen offset:3072 sc1
    v_mfma_f32_16x16x32_bf16 v[40:43], v[100:103], a[192:195], v[40:43]
    ds_read_b128 v[124:127], v1 offset:15360
    v_mfma_f32_16x16x32_bf16 v[44:47], v[100:103], a[196:199], v[44:47]
    s_waitcnt lgkmcnt(5)
    v_mfma_f32_16x16x32_bf16 v[48:51], v[104:107], a[192:195], v[48:51]
    ds_read_b128 v[96:99], v1 offset:16384
    v_mfma_f32_16x16x32_bf16 v[52:55], v[104:107], a[196:199], v[52:55]
    s_waitcnt lgkmcnt(5)
    buffer_load_dwordx4 a[236:239], v1, s[4:7], s45 offen offset:3072 sc1
    v_mfma_f32_16x16x32_bf16 v[56:59], v[108:111], a[192:195], v[56:59]
    s_add_u32 s44, s44, 4096
    ds_read_b128 v[100:103], v1 offset:17408
    v_mfma_f32_16x16x32_bf16 v[60:63], v[108:111], a[196:199], v[60:63]
    s_waitcnt vmcnt(8) lgkmcnt(5)
    v_mfma_f32_16x16x32_bf16 v[32:35], v[112:115], a[200:203], v[32:35]
    ds_read_b128 v[104:107], v1 offset:18432
    v_mfma_f32_16x16x32_bf16 v[36:39], v[112:115], a[204:207], v[36:39]
    s_waitcnt lgkmcnt(5)
    buffer_load_dwordx4 a[240:243], v1, s[4:7], s44 offen offset:0 sc1
    v_mfma_f32_16x16x32_bf16 v[40:43], v[116:119], a[200:203], v[40:43]
    s_add_u32 s45, s45, 4096
    ds_read_b128 v[108:111], v1 offset:19456
    v_mfma_f32_16x16x32_bf16 v[44:47], v[116:119], a[204:207], v[44:47]
    s_waitcnt lgkmcnt(5)
    v_mfma_f32_16x16x32_bf16 v[48:51], v[120:123], a[200:203], v[48:51]
    ds_read_b128 v[112:115], v1 offset:20480
    v_mfma_f32_16x16x32_bf16 v[52:55], v[120:123], a[204:207], v[52:55]
    s_waitcnt lgkmcnt(5)
    buffer_load_dwordx4 a[244:247], v1, s[4:7], s45 offen offset:0 sc1
    v_mfma_f32_16x16x32_bf16 v[56:59], v[124:127], a[200:203], v[56:59]
    ds_read_b128 v[116:119], v1 offset:21504
    v_mfma_f32_16x16x32_bf16 v[60:63], v[124:127], a[204:207], v[60:63]
    s_waitcnt vmcnt(8) lgkmcnt(5)
    v_mfma_f32_16x16x32_bf16 v[32:35], v[96:99], a[208:211], v[32:35]
    ds_read_b128 v[120:123], v1 offset:22528
    v_mfma_f32_16x16x32_bf16 v[36:39], v[96:99], a[212:215], v[36:39]
    s_waitcnt lgkmcnt(5)
    buffer_load_dword v197, v196, s[4:7], s2 offen sc1
    v_mfma_f32_16x16x32_bf16 v[40:43], v[100:103], a[208:211], v[40:43]
    ds_read_b128 v[124:127], v1 offset:23552
    v_mfma_f32_16x16x32_bf16 v[44:47], v[100:103], a[212:215], v[44:47]
    s_waitcnt lgkmcnt(5)
    v_mfma_f32_16x16x32_bf16 v[48:51], v[104:107], a[208:211], v[48:51]
    ds_read_b128 v[96:99], v1 offset:24576
    v_mfma_f32_16x16x32_bf16 v[52:55], v[104:107], a[212:215], v[52:55]
    s_waitcnt lgkmcnt(5)
    buffer_load_dwordx4 a[248:251], v1, s[4:7], s44 offen offset:1024 sc1
    v_mfma_f32_16x16x32_bf16 v[56:59], v[108:111], a[208:211], v[56:59]
    ds_read_b128 v[100:103], v1 offset:25600
    v_mfma_f32_16x16x32_bf16 v[60:63], v[108:111], a[212:215], v[60:63]
    s_waitcnt vmcnt(8) lgkmcnt(5)
    v_mfma_f32_16x16x32_bf16 v[32:35], v[112:115], a[216:219], v[32:35]
    ds_read_b128 v[104:107], v1 offset:26624
    v_mfma_f32_16x16x32_bf16 v[36:39], v[112:115], a[220:223], v[36:39]
    s_waitcnt lgkmcnt(5)
    buffer_load_dwordx4 a[252:255], v1, s[4:7], s45 offen offset:1024 sc1
    v_mfma_f32_16x16x32_bf16 v[40:43], v[116:119], a[216:219], v[40:43]
    ds_read_b128 v[108:111], v1 offset:27648
    v_mfma_f32_16x16x32_bf16 v[44:47], v[116:119], a[220:223], v[44:47]
    s_waitcnt lgkmcnt(5)
    v_mfma_f32_16x16x32_bf16 v[48:51], v[120:123], a[216:219], v[48:51]
    ds_read_b128 v[112:115], v1 offset:28672
    v_mfma_f32_16x16x32_bf16 v[52:55], v[120:123], a[220:223], v[52:55]
    s_waitcnt lgkmcnt(5)
    buffer_load_dwordx4 v[128:131], v1, s[4:7], s44 offen offset:2048 sc1
    v_mfma_f32_16x16x32_bf16 v[56:59], v[124:127], a[216:219], v[56:59]
    ds_read_b128 v[116:119], v1 offset:29696
    v_mfma_f32_16x16x32_bf16 v[60:63], v[124:127], a[220:223], v[60:63]
    s_waitcnt vmcnt(8) lgkmcnt(5)
    v_mfma_f32_16x16x32_bf16 v[32:35], v[96:99], a[224:227], v[32:35]
    ds_read_b128 v[120:123], v1 offset:30720
    v_mfma_f32_16x16x32_bf16 v[36:39], v[96:99], a[228:231], v[36:39]
    s_waitcnt lgkmcnt(5)
    buffer_load_dwordx4 v[132:135], v1, s[4:7], s45 offen offset:2048 sc1
    v_mfma_f32_16x16x32_bf16 v[40:43], v[100:103], a[224:227], v[40:43]
    ds_read_b128 v[124:127], v1 offset:31744
    v_mfma_f32_16x16x32_bf16 v[44:47], v[100:103], a[228:231], v[44:47]
    s_waitcnt lgkmcnt(5)
    v_mfma_f32_16x16x32_bf16 v[48:51], v[104:107], a[224:227], v[48:51]
    ds_read_b128 v[96:99], v1 offset:32768
    v_mfma_f32_16x16x32_bf16 v[52:55], v[104:107], a[228:231], v[52:55]
    s_waitcnt lgkmcnt(5)
    buffer_load_dwordx4 v[136:139], v1, s[4:7], s44 offen offset:3072 sc1
    v_mfma_f32_16x16x32_bf16 v[56:59], v[108:111], a[224:227], v[56:59]
    ds_read_b128 v[100:103], v1 offset:33792
    v_mfma_f32_16x16x32_bf16 v[60:63], v[108:111], a[228:231], v[60:63]
    s_waitcnt vmcnt(8) lgkmcnt(5)
    v_mfma_f32_16x16x32_bf16 v[32:35], v[112:115], a[232:235], v[32:35]
    ds_read_b128 v[104:107], v1 offset:34816
    v_mfma_f32_16x16x32_bf16 v[36:39], v[112:115], a[236:239], v[36:39]
    s_waitcnt lgkmcnt(5)
    buffer_load_dwordx4 v[140:143], v1, s[4:7], s45 offen offset:3072 sc1
    v_mfma_f32_16x16x32_bf16 v[40:43], v[116:119], a[232:235], v[40:43]
    s_add_u32 s44, s44, 4096
    ds_read_b128 v[108:111], v1 offset:35840
    v_mfma_f32_16x16x32_bf16 v[44:47], v[116:119], a[236:239], v[44:47]
    s_waitcnt lgkmcnt(5)
    v_mfma_f32_16x16x32_bf16 v[48:51], v[120:123], a[232:235], v[48:51]
    ds_read_b128 v[112:115], v1 offset:36864
    v_mfma_f32_16x16x32_bf16 v[52:55], v[120:123], a[236:239], v[52:55]
    s_waitcnt lgkmcnt(5)
    buffer_load_dwordx4 v[144:147], v1, s[4:7], s44 offen offset:0 sc1
    v_mfma_f32_16x16x32_bf16 v[56:59], v[124:127], a[232:235], v[56:59]
    s_add_u32 s45, s45, 4096
    ds_read_b128 v[116:119], v1 offset:37888
    v_mfma_f32_16x16x32_bf16 v[60:63], v[124:127], a[236:239], v[60:63]
    s_waitcnt vmcnt(8) lgkmcnt(5)
    v_mfma_f32_16x16x32_bf16 v[32:35], v[96:99], a[240:243], v[32:35]
    ds_read_b128 v[120:123], v1 offset:38912
    v_mfma_f32_16x16x32_bf16 v[36:39], v[96:99], a[244:247], v[36:39]
    s_waitcnt lgkmcnt(5)
    buffer_load_dwordx4 v[148:151], v1, s[4:7], s45 offen offset:0 sc1
    v_mfma_f32_16x16x32_bf16 v[40:43], v[100:103], a[240:243], v[40:43]
    ds_read_b128 v[124:127], v1 offset:39936
    v_mfma_f32_16x16x32_bf16 v[44:47], v[100:103], a[244:247], v[44:47]
    s_waitcnt lgkmcnt(5)
    v_mfma_f32_16x16x32_bf16 v[48:51], v[104:107], a[240:243], v[48:51]
    ds_read_b128 v[96:99], v1 offset:40960
    v_mfma_f32_16x16x32_bf16 v[52:55], v[104:107], a[244:247], v[52:55]
    s_waitcnt lgkmcnt(5)
    buffer_load_dwordx4 v[152:155], v1, s[4:7], s44 offen offset:1024 sc1
    v_mfma_f32_16x16x32_bf16 v[56:59], v[108:111], a[240:243], v[56:59]
    ds_read_b128 v[100:103], v1 offset:41984
    v_mfma_f32_16x16x32_bf16 v[60:63], v[108:111], a[244:247], v[60:63]
    s_waitcnt vmcnt(7) lgkmcnt(5)
    v_mfma_f32_16x16x32_bf16 v[32:35], v[112:115], a[248:251], v[32:35]
    ds_read_b128 v[104:107], v1 offset:43008
    v_mfma_f32_16x16x32_bf16 v[36:39], v[112:115], a[252:255], v[36:39]
    s_waitcnt lgkmcnt(5)
    buffer_load_dwordx4 v[156:159], v1, s[4:7], s45 offen offset:1024 sc1
    v_mfma_f32_16x16x32_bf16 v[40:43], v[116:119], a[248:251], v[40:43]
    ds_read_b128 v[108:111], v1 offset:44032
    v_mfma_f32_16x16x32_bf16 v[44:47], v[116:119], a[252:255], v[44:47]
    s_waitcnt lgkmcnt(5)
    v_mfma_f32_16x16x32_bf16 v[48:51], v[120:123], a[248:251], v[48:51]
    ds_read_b128 v[112:115], v1 offset:45056
    v_mfma_f32_16x16x32_bf16 v[52:55], v[120:123], a[252:255], v[52:55]
    s_waitcnt lgkmcnt(5)
    buffer_load_dwordx4 v[160:163], v1, s[4:7], s44 offen offset:2048 sc1
    v_mfma_f32_16x16x32_bf16 v[56:59], v[124:127], a[248:251], v[56:59]
    ds_read_b128 v[116:119], v1 offset:46080
    v_mfma_f32_16x16x32_bf16 v[60:63], v[124:127], a[252:255], v[60:63]
    s_waitcnt vmcnt(7) lgkmcnt(5)
    v_mfma_f32_16x16x32_bf16 v[32:35], v[96:99], v[128:131], v[32:35]
    ds_read_b128 v[120:123], v1 offset:47104
    v_mfma_f32_16x16x32_bf16 v[36:39], v[96:99], v[132:135], v[36:39]
    s_waitcnt lgkmcnt(5)
    buffer_load_dwordx4 v[164:167], v1, s[4:7], s45 offen offset:2048 sc1
    v_mfma_f32_16x16x32_bf16 v[40:43], v[100:103], v[128:131], v[40:43]
    ds_read_b128 v[124:127], v1 offset:48128
    v_mfma_f32_16x16x32_bf16 v[44:47], v[100:103], v[132:135], v[44:47]
    s_waitcnt lgkmcnt(5)
    v_mfma_f32_16x16x32_bf16 v[48:51], v[104:107], v[128:131], v[48:51]
    ds_read_b128 v[96:99], v1 offset:49152
    v_mfma_f32_16x16x32_bf16 v[52:55], v[104:107], v[132:135], v[52:55]
    s_waitcnt lgkmcnt(5)
    buffer_load_dwordx4 v[168:171], v1, s[4:7], s44 offen offset:3072 sc1
    v_mfma_f32_16x16x32_bf16 v[56:59], v[108:111], v[128:131], v[56:59]
    ds_read_b128 v[100:103], v1 offset:50176
    v_mfma_f32_16x16x32_bf16 v[60:63], v[108:111], v[132:135], v[60:63]
    s_waitcnt vmcnt(7) lgkmcnt(5)
    v_mfma_f32_16x16x32_bf16 v[32:35], v[112:115], v[136:139], v[32:35]
    ds_read_b128 v[104:107], v1 offset:51200
    v_mfma_f32_16x16x32_bf16 v[36:39], v[112:115], v[140:143], v[36:39]
    s_waitcnt lgkmcnt(5)
    buffer_load_dwordx4 v[172:175], v1, s[4:7], s45 offen offset:3072 sc1
    v_mfma_f32_16x16x32_bf16 v[40:43], v[116:119], v[136:139], v[40:43]
    s_add_u32 m0, s47, 106496
    ds_read_b128 v[108:111], v1 offset:52224
    v_mfma_f32_16x16x32_bf16 v[44:47], v[116:119], v[140:143], v[44:47]
    s_waitcnt lgkmcnt(5)
    v_mfma_f32_16x16x32_bf16 v[48:51], v[120:123], v[136:139], v[48:51]
    ds_read_b128 v[112:115], v1 offset:53248
    v_mfma_f32_16x16x32_bf16 v[52:55], v[120:123], v[140:143], v[52:55]
    s_waitcnt lgkmcnt(5)
    buffer_load_dwordx4 v242, s[4:7], m0 offen sc1 lds
    v_mfma_f32_16x16x32_bf16 v[56:59], v[124:127], v[136:139], v[56:59]
    s_add_u32 m0, s47, 110592
    ds_read_b128 v[116:119], v1 offset:54272
    v_mfma_f32_16x16x32_bf16 v[60:63], v[124:127], v[140:143], v[60:63]
    s_waitcnt vmcnt(7) lgkmcnt(5)
    v_mfma_f32_16x16x32_bf16 v[32:35], v[96:99], v[144:147], v[32:35]
    ds_read_b128 v[120:123], v1 offset:55296
    v_mfma_f32_16x16x32_bf16 v[36:39], v[96:99], v[148:151], v[36:39]
    s_waitcnt lgkmcnt(5)
    buffer_load_dwordx4 v242, s[4:7], m0 offen sc1 lds
    v_mfma_f32_16x16x32_bf16 v[40:43], v[100:103], v[144:147], v[40:43]
    s_add_u32 m0, s47, 114688
    ds_read_b128 v[124:127], v1 offset:56320
    v_mfma_f32_16x16x32_bf16 v[44:47], v[100:103], v[148:151], v[44:47]
    s_waitcnt lgkmcnt(5)
    v_mfma_f32_16x16x32_bf16 v[48:51], v[104:107], v[144:147], v[48:51]
    ds_read_b128 v[96:99], v1 offset:57344
    v_mfma_f32_16x16x32_bf16 v[52:55], v[104:107], v[148:151], v[52:55]
    s_waitcnt lgkmcnt(5)
    buffer_load_dwordx4 v242, s[4:7], m0 offen sc1 lds
    v_mfma_f32_16x16x32_bf16 v[56:59], v[108:111], v[144:147], v[56:59]
    s_add_u32 m0, s47, 118784
    ds_read_b128 v[100:103], v1 offset:58368
    v_mfma_f32_16x16x32_bf16 v[60:63], v[108:111], v[148:151], v[60:63]
    s_waitcnt vmcnt(7) lgkmcnt(5)
    v_mfma_f32_16x16x32_bf16 v[32:35], v[112:115], v[152:155], v[32:35]
    ds_read_b128 v[104:107], v1 offset:59392
    v_mfma_f32_16x16x32_bf16 v[36:39], v[112:115], v[156:159], v[36:39]
    s_waitcnt lgkmcnt(5)
    buffer_load_dwordx4 v242, s[4:7], m0 offen sc1 lds
    v_mfma_f32_16x16x32_bf16 v[40:43], v[116:119], v[152:155], v[40:43]
    s_add_u32 m0, s47, 122880
    ds_read_b128 v[108:111], v1 offset:60416
    v_mfma_f32_16x16x32_bf16 v[44:47], v[116:119], v[156:159], v[44:47]
    s_waitcnt lgkmcnt(5)
    v_mfma_f32_16x16x32_bf16 v[48:51], v[120:123], v[152:155], v[48:51]
    ds_read_b128 v[112:115], v1 offset:61440
    v_mfma_f32_16x16x32_bf16 v[52:55], v[120:123], v[156:159], v[52:55]
    s_waitcnt lgkmcnt(5)
    buffer_load_dwordx4 v242, s[4:7], m0 offen sc1 lds
    v_mfma_f32_16x16x32_bf16 v[56:59], v[124:127], v[152:155], v[56:59]
    s_add_u32 m0, s47, 126976
    ds_read_b128 v[116:119], v1 offset:62464
    v_mfma_f32_16x16x32_bf16 v[60:63], v[124:127], v[156:159], v[60:63]
    s_waitcnt vmcnt(7) lgkmcnt(5)
    v_mfma_f32_16x16x32_bf16 v[32:35], v[96:99], v[160:163], v[32:35]
    ds_read_b128 v[120:123], v1 offset:63488
    v_mfma_f32_16x16x32_bf16 v[36:39], v[96:99], v[164:167], v[36:39]
    s_waitcnt lgkmcnt(5)
    buffer_load_dwordx4 v242, s[4:7], m0 offen sc1 lds
    v_mfma_f32_16x16x32_bf16 v[40:43], v[100:103], v[160:163], v[40:43]
    s_add_u32 m0, s47, 131072
    ds_read_b128 v[124:127], v1 offset:64512
    v_mfma_f32_16x16x32_bf16 v[44:47], v[100:103], v[164:167], v[44:47]
    s_waitcnt lgkmcnt(5)
    v_mfma_f32_16x16x32_bf16 v[48:51], v[104:107], v[160:163], v[48:51]
    ds_read_b128 v[96:99], v10 offset:0
    v_mfma_f32_16x16x32_bf16 v[52:55], v[104:107], v[164:167], v[52:55]
    s_waitcnt lgkmcnt(5)
    buffer_load_dwordx4 v242, s[4:7], m0 offen sc1 lds
    v_mfma_f32_16x16x32_bf16 v[56:59], v[108:111], v[160:163], v[56:59]
    s_add_u32 m0, s47, 135168
    ds_read_b128 v[100:103], v10 offset:1024
    v_mfma_f32_16x16x32_bf16 v[60:63], v[108:111], v[164:167], v[60:63]
    s_waitcnt vmcnt(7) lgkmcnt(5)
    v_mfma_f32_16x16x32_bf16 v[32:35], v[112:115], v[168:171], v[32:35]
    ds_read_b128 v[104:107], v10 offset:2048
    v_mfma_f32_16x16x32_bf16 v[36:39], v[112:115], v[172:175], v[36:39]
    s_waitcnt lgkmcnt(5)
    buffer_load_dwordx4 v242, s[4:7], m0 offen sc1 lds
    v_mfma_f32_16x16x32_bf16 v[40:43], v[116:119], v[168:171], v[40:43]
    s_add_u32 m0, s47, 139264
    ds_read_b128 v[108:111], v10 offset:3072
    v_mfma_f32_16x16x32_bf16 v[44:47], v[116:119], v[172:175], v[44:47]
    s_waitcnt lgkmcnt(5)
    v_mfma_f32_16x16x32_bf16 v[48:51], v[120:123], v[168:171], v[48:51]
    ds_read_b128 v[112:115], v10 offset:4096
    v_mfma_f32_16x16x32_bf16 v[52:55], v[120:123], v[172:175], v[52:55]
    s_waitcnt lgkmcnt(5)
    buffer_load_dwordx4 v242, s[4:7], m0 offen sc1 lds
    v_mfma_f32_16x16x32_bf16 v[56:59], v[124:127], v[168:171], v[56:59]
    s_add_u32 m0, s47, 143360
    ds_read_b128 v[116:119], v10 offset:5120
    v_mfma_f32_16x16x32_bf16 v[60:63], v[124:127], v[172:175], v[60:63]
    s_waitcnt lgkmcnt(5)
    s_waitcnt vmcnt(23)
    v_cmp_ne_u32 vcc, s28, v197
    s_cbranch_vccnz L_pW2_re
L_pW2_ok:
    v_mfma_f32_16x16x32_bf16 v[64:67], v[96:99], a[176:179], 0
    ds_read_b128 v[120:123], v10 offset:6144
    v_mfma_f32_16x16x32_bf16 v[68:71], v[96:99], a[180:183], 0
    s_waitcnt lgkmcnt(5)
    buffer_load_dwordx4 v242, s[4:7], m0 offen sc1 lds
    v_exp_f32 v184, -v32
    v_mfma_f32_16x16x32_bf16 v[72:75], v[100:103], a[176:179], 0
    s_add_u32 m0, s47, 147456
    ds_read_b128 v[124:127], v10 offset:7168
    v_mfma_f32_16x16x32_bf16 v[76:79], v[100:103], a[180:183], 0
    s_waitcnt lgkmcnt(5)
    v_mfma_f32_16x16x32_bf16 v[80:83], v[104:107], a[176:179], 0
    ds_read_b128 v[96:99], v10 offset:8192
    v_mul_f32 v32, v32, v34
    v_mfma_f32_16x16x32_bf16 v[84:87], v[104:107], a[180:183], 0
    s_waitcnt lgkmcnt(5)
    buffer_load_dwordx4 v242, s[4:7], m0 offen sc1 lds
    v_exp_f32 v185, -v33
    v_mfma_f32_16x16x32_bf16 v[64:67], v[108:111], a[184:187], v[64:67]
    s_add_u32 m0, s47, 151552
    ds_read_b128 v[100:103], v10 offset:9216
    v_mul_f32 v33, v33, v35
    v_mfma_f32_16x16x32_bf16 v[68:71], v[108:111], a[188:191], v[68:71]
    s_waitcnt lgkmcnt(5)
    v_exp_f32 v186, -v40
    v_mfma_f32_16x16x32_bf16 v[72:75], v[112:115], a[184:187], v[72:75]
    ds_read_b128 v[104:107], v10 offset:10240
    v_fma_f32 v184, v184, s65, s65
    v_mfma_f32_16x16x32_bf16 v[76:79], v[112:115], a[188:191], v[76:79]
    s_waitcnt lgkmcnt(5)
    buffer_load_dwordx4 v242, s[4:7], m0 offen sc1 lds
    v_rcp_f32 v184, v184
    v_mfma_f32_16x16x32_bf16 v[80:83], v[116:119], a[184:187], v[80:83]
    s_add_u32 m0, s47, 155648
    ds_read_b128 v[108:111], v10 offset:11264
    v_fma_f32 v185, v185, s65, s65
    v_mfma_f32_16x16x32_bf16 v[84:87], v[116:119], a[188:191], v[84:87]
    s_waitcnt lgkmcnt(5)
    v_rcp_f32 v185, v185
    v_mfma_f32_16x16x32_bf16 v[64:67], v[120:123], a[192:195], v[64:67]
    ds_read_b128 v[112:115], v10 offset:12288
    v_mul_f32 v32, v32, v184
    v_mfma_f32_16x16x32_bf16 v[68:71], v[120:123], a[196:199], v[68:71]
    s_waitcnt lgkmcnt(5)
    buffer_load_dwordx4 v242, s[4:7], m0 offen sc1 lds
    v_exp_f32 v187, -v41
    v_mfma_f32_16x16x32_bf16 v[72:75], v[124:127], a[192:195], v[72:75]
    s_add_u32 m0, s47, 159744
    ds_read_b128 v[116:119], v10 offset:13312
    v_mul_f32 v33, v33, v185
    v_mfma_f32_16x16x32_bf16 v[76:79], v[124:127], a[196:199], v[76:79]
    s_waitcnt lgkmcnt(5)
    v_exp_f32 v188, -v48
    v_mfma_f32_16x16x32_bf16 v[80:83], v[96:99], a[192:195], v[80:83]
    ds_read_b128 v[120:123], v10 offset:14336
    v_cvt_pk_bf16_f32 v176, v32, v33
    v_mfma_f32_16x16x32_bf16 v[84:87], v[96:99], a[196:199], v[84:87]
    s_waitcnt lgkmcnt(5)
    buffer_load_dwordx4 v242, s[4:7], m0 offen sc1 lds
    v_exp_f32 v189, -v49
    v_mfma_f32_16x16x32_bf16 v[64:67], v[100:103], a[200:203], v[64:67]
    s_add_u32 s48, s49, 0
    ds_read_b128 v[124:127], v10 offset:15360
    v_mul_f32 v40, v40, v42
    v_mfma_f32_16x16x32_bf16 v[68:71], v[100:103], a[204:207], v[68:71]
    s_waitcnt lgkmcnt(5)
    v_exp_f32 v184, -v56
    v_mfma_f32_16x16x32_bf16 v[72:75], v[104:107], a[200:203], v[72:75]
    ds_read_b128 v[96:99], v10 offset:16384
    v_mul_f32 v41, v41, v43
    v_mfma_f32_16x16x32_bf16 v[76:79], v[104:107], a[204:207], v[76:79]
    s_waitcnt lgkmcnt(5)
    buffer_load_dwordx4 a[0:3], v1, s[4:7], s48 offen offset:0 sc1
    v_exp_f32 v185, -v57
    v_mfma_f32_16x16x32_bf16 v[80:83], v[108:111], a[200:203], v[80:83]
    ds_read_b128 v[100:103], v10 offset:17408
    v_fma_f32 v186, v186, s65, s65
    v_mfma_f32_16x16x32_bf16 v[84:87], v[108:111], a[204:207], v[84:87]
    s_waitcnt lgkmcnt(5)
    v_rcp_f32 v186, v186
    v_mfma_f32_16x16x32_bf16 v[64:67], v[112:115], a[208:211], v[64:67]
    ds_read_b128 v[104:107], v10 offset:18432
    v_fma_f32 v187, v187, s65, s65
    v_mfma_f32_16x16x32_bf16 v[68:71], v[112:115], a[212:215], v[68:71]
    s_waitcnt lgkmcnt(5)
    buffer_load_dwordx4 a[4:7], v1, s[4:7], s48 offen offset:1024 sc1
    v_rcp_f32 v187, v187
    v_mfma_f32_16x16x32_bf16 v[72:75], v[116:119], a[208:211], v[72:75]
    ds_read_b128 v[108:111], v10 offset:19456
    v_mul_f32 v40, v40, v186
    v_mfma_f32_16x16x32_bf16 v[76:79], v[116:119], a[212:215], v[76:79]
    s_waitcnt lgkmcnt(5)
    v_mul_f32 v41, v41, v187
    v_mul_f32 v48, v48, v50
    v_mfma_f32_16x16x32_bf16 v[80:83], v[120:123], a[208:211], v[80:83]
    ds_read_b128 v[112:115], v10 offset:20480
    v_cvt_pk_bf16_f32 v177, v40, v41
    v_mfma_f32_16x16x32_bf16 v[84:87], v[120:123], a[212:215], v[84:87]
    s_waitcnt lgkmcnt(5)
    buffer_load_dwordx4 a[8:11], v1, s[4:7], s48 offen offset:2048 sc1
    v_exp_f32 v186, -v36
    v_mfma_f32_16x16x32_bf16 v[64:67], v[124:127], a[216:219], v[64:67]
    ds_read_b128 v[116:119], v10 offset:21504
    v_mul_f32 v49, v49, v51
    v_mfma_f32_16x16x32_bf16 v[68:71], v[124:127], a[220:223], v[68:71]
    s_waitcnt lgkmcnt(5)
    v_exp_f32 v187, -v37
    v_mfma_f32_16x16x32_bf16 v[72:75], v[96:99], a[216:219], v[72:75]
    ds_read_b128 v[120:123], v10 offset:22528
    v_fma_f32 v188, v188, s65, s65
    v_mfma_f32_16x16x32_bf16 v[76:79], v[96:99], a[220:223], v[76:79]
    s_waitcnt lgkmcnt(5)
    buffer_load_dwordx4 a[12:15], v1, s[4:7], s48 offen offset:3072 sc1
    v_rcp_f32 v188, v188
    v_mfma_f32_16x16x32_bf16 v[80:83], v[100:103], a[216:219], v[80:83]
    s_add_u32 s48, s49, 8192
    ds_read_b128 v[124:127], v10 offset:23552
    v_fma_f32 v189, v189, s65, s65
    v_mfma_f32_16x16x32_bf16 v[84:87], v[100:103], a[220:223], v[84:87]
    s_waitcnt lgkmcnt(5)
    v_rcp_f32 v189, v189
    v_mfma_f32_16x16x32_bf16 v[64:67], v[104:107], a[224:227], v[64:67]
    ds_read_b128 v[96:99], v10 offset:24576
    v_mul_f32 v48, v48, v188
    v_mfma_f32_16x16x32_bf16 v[68:71], v[104:107], a[228:231], v[68:71]
    s_waitcnt lgkmcnt(5)
    buffer_load_dwordx4 a[32:35], v1, s[4:7], s48 offen offset:0 sc1
    v_mul_f32 v49, v49, v189
    v_mfma_f32_16x16x32_bf16 v[72:75], v[108:111], a[224:227], v[72:75]
    ds_read_b128 v[100:103], v10 offset:25600
    v_cvt_pk_bf16_f32 v178, v48, v49
    v_mfma_f32_16x16x32_bf16 v[76:79], v[108:111], a[228:231], v[76:79]
    s_waitcnt lgkmcnt(5)
    v_exp_f32 v188, -v44
    v_mfma_f32_16x16x32_bf16 v[80:83], v[112:115], a[224:227], v[80:83]
    ds_read_b128 v[104:107], v10 offset:26624
    v_mul_f32 v56, v56, v58
    v_mfma_f32_16x16x32_bf16 v[84:87], v[112:115], a[228:231], v[84:87]
    s_waitcnt lgkmcnt(5)
    buffer_load_dwordx4 a[36:39], v1, s[4:7], s48 offen offset:1024 sc1
    v_exp_f32 v189, -v45
    v_mfma_f32_16x16x32_bf16 v[64:67], v[116:119], a[232:235], v[64:67]
    ds_read_b128 v[108:111], v10 offset:27648
    v_mul_f32 v57, v57, v59
    v_mfma_f32_16x16x32_bf16 v[68:71], v[116:119], a[236:239], v[68:71]
    s_waitcnt lgkmcnt(5)
    v_fma_f32 v184, v184, s65, s65
    v_fma_f32 v185, v185, s65, s65
    v_mfma_f32_16x16x32_bf16 v[72:75], v[120:123], a[232:235], v[72:75]
    ds_read_b128 v[112:115], v10 offset:28672
    v_mul_f32 v36, v36, v38
    v_mfma_f32_16x16x32_bf16 v[76:79], v[120:123], a[236:239], v[76:79]
    s_waitcnt lgkmcnt(5)
    buffer_load_dwordx4 a[40:43], v1, s[4:7], s48 offen offset:2048 sc1
    v_rcp_f32 v184, v184
    v_mfma_f32_16x16x32_bf16 v[80:83], v[124:127], a[232:235], v[80:83]
    ds_read_b128 v[116:119], v10 offset:29696
    v_mul_f32 v56, v56, v184
    v_mfma_f32_16x16x32_bf16 v[84:87], v[124:127], a[236:239], v[84:87]
    s_waitcnt lgkmcnt(5)
    v_rcp_f32 v185, v185
    v_mfma_f32_16x16x32_bf16 v[64:67], v[96:99], a[240:243], v[64:67]
    ds_read_b128 v[120:123], v10 offset:30720
    v_mul_f32 v57, v57, v185
    v_mfma_f32_16x16x32_bf16 v[68:71], v[96:99], a[244:247], v[68:71]
    s_waitcnt lgkmcnt(5)
    buffer_load_dwordx4 a[44:47], v1, s[4:7], s48 offen offset:3072 sc1
    v_exp_f32 v184, -v52
    v_mfma_f32_16x16x32_bf16 v[72:75], v[100:103], a[240:243], v[72:75]
    s_add_u32 s48, s49, 16384
    ds_read_b128 v[124:127], v10 offset:31744
    v_cvt_pk_bf16_f32 v179, v56, v57
    v_mfma_f32_16x16x32_bf16 v[76:79], v[100:103], a[244:247], v[76:79]
    s_waitcnt lgkmcnt(5)
    v_exp_f32 v185, -v53
    v_mfma_f32_16x16x32_bf16 v[80:83], v[104:107], a[240:243], v[80:83]
    ds_read_b128 v[96:99], v10 offset:32768
    v_mul_f32 v37, v37, v39
    v_mfma_f32_16x16x32_bf16 v[84:87], v[104:107], a[244:247], v[84:87]
    s_waitcnt lgkmcnt(5)
    buffer_store_dwordx4 v[176:179], v1, s[4:7], s78 offen offset:0 sc1
    v_mfma_f32_16x16x32_bf16 v[64:67], v[108:111], a[248:251], v[64:67]
    ds_read_b128 v[100:103], v10 offset:33792
    v_fma_f32 v186, v186, s65, s65
    v_mfma_f32_16x16x32_bf16 v[68:71], v[108:111], a[252:255], v[68:71]
    s_waitcnt lgkmcnt(5)
    v_rcp_f32 v186, v186
    v_mfma_f32_16x16x32_bf16 v[72:75], v[112:115], a[248:251], v[72:75]
    ds_read_b128 v[104:107], v10 offset:34816
    v_fma_f32 v187, v187, s65, s65
    v_mfma_f32_16x16x32_bf16 v[76:79], v[112:115], a[252:255], v[76:79]
    s_waitcnt lgkmcnt(5)
    buffer_load_dwordx4 a[64:67], v1, s[4:7], s48 offen offset:0 sc1
    v_rcp_f32 v187, v187
    v_mfma_f32_16x16x32_bf16 v[80:83], v[116:119], a[248:251], v[80:83]
    ds_read_b128 v[108:111], v10 offset:35840
    v_mul_f32 v36, v36, v186
    v_mfma_f32_16x16x32_bf16 v[84:87], v[116:119], a[252:255], v[84:87]
    s_waitcnt lgkmcnt(5)
    v_mul_f32 v37, v37, v187
    v_mul_f32 v44, v44, v46
    v_mfma_f32_16x16x32_bf16 v[64:67], v[120:123], v[128:131], v[64:67]
    ds_read_b128 v[112:115], v10 offset:36864
    v_cvt_pk_bf16_f32 v180, v36, v37
    v_mfma_f32_16x16x32_bf16 v[68:71], v[120:123], v[132:135], v[68:71]
    s_waitcnt lgkmcnt(5)
    buffer_load_dwordx4 a[68:71], v1, s[4:7], s48 offen offset:1024 sc1
    v_exp_f32 v186, -v60
    v_mfma_f32_16x16x32_bf16 v[72:75], v[124:127], v[128:131], v[72:75]
    ds_read_b128 v[116:119], v10 offset:37888
    v_mul_f32 v45, v45, v47
    v_mfma_f32_16x16x32_bf16 v[76:79], v[124:127], v[132:135], v[76:79]
    s_waitcnt lgkmcnt(5)
    v_exp_f32 v187, -v61
    v_mfma_f32_16x16x32_bf16 v[80:83], v[96:99], v[128:131], v[80:83]
    ds_read_b128 v[120:123], v10 offset:38912
    v_fma_f32 v188, v188, s65, s65
    v_mfma_f32_16x16x32_bf16 v[84:87], v[96:99], v[132:135], v[84:87]
    s_waitcnt lgkmcnt(5)
    buffer_load_dwordx4 a[72:75], v1, s[4:7], s48 offen offset:2048 sc1
    v_rcp_f32 v188, v188
    v_mfma_f32_16x16x32_bf16 v[64:67], v[100:103], v[136:139], v[64:67]
    ds_read_b128 v[124:127], v10 offset:39936
    v_fma_f32 v189, v189, s65, s65
    v_mfma_f32_16x16x32_bf16 v[68:71], v[100:103], v[140:143], v[68:71]
    s_waitcnt vmcnt(12) lgkmcnt(5)
    s_barrier
    v_rcp_f32 v189, v189
    v_mfma_f32_16x16x32_bf16 v[72:75], v[104:107], v[136:139], v[72:75]
    s_add_u32 m0, s47, 81920
    ds_read_b128 v[96:99], v10 offset:40960
    v_mul_f32 v44, v44, v188
    v_mfma_f32_16x16x32_bf16 v[76:79], v[104:107], v[140:143], v[76:79]
    s_waitcnt lgkmcnt(5)
    buffer_load_dwordx4 v243, s[4:7], m0 offen sc1 lds
    v_mul_f32 v45, v45, v189
    v_mfma_f32_16x16x32_bf16 v[80:83], v[108:111], v[136:139], v[80:83]
    s_add_u32 m0, s47, 86016
    ds_read_b128 v[100:103], v10 offset:41984
    v_cvt_pk_bf16_f32 v181, v44, v45
    v_mfma_f32_16x16x32_bf16 v[84:87], v[108:111], v[140:143], v[84:87]
    s_waitcnt lgkmcnt(5)
    v_mul_f32 v52, v52, v54
    v_mul_f32 v53, v53, v55
    v_mfma_f32_16x16x32_bf16 v[64:67], v[112:115], v[144:147], v[64:67]
    ds_read_b128 v[104:107], v10 offset:43008
    v_fma_f32 v184, v184, s65, s65
    v_mfma_f32_16x16x32_bf16 v[68:71], v[112:115], v[148:151], v[68:71]
    s_waitcnt lgkmcnt(5)
    buffer_load_dwordx4 v243, s[4:7], m0 offen sc1 lds
    v_rcp_f32 v184, v184
    v_mfma_f32_16x16x32_bf16 v[72:75], v[116:119], v[144:147], v[72:75]
    s_add_u32 m0, s47, 90112
    ds_read_b128 v[108:111], v10 offset:44032
    v_fma_f32 v185, v185, s65, s65
    v_mfma_f32_16x16x32_bf16 v[76:79], v[116:119], v[148:151], v[76:79]
    s_waitcnt lgkmcnt(5)
    v_rcp_f32 v185, v185
    v_mfma_f32_16x16x32_bf16 v[80:83], v[120:123], v[144:147], v[80:83]
    ds_read_b128 v[112:115], v10 offset:45056
    v_mul_f32 v52, v52, v184
    v_mfma_f32_16x16x32_bf16 v[84:87], v[120:123], v[148:151], v[84:87]
    s_waitcnt lgkmcnt(5)
    buffer_load_dwordx4 v243, s[4:7], m0 offen sc1 lds
    v_mul_f32 v53, v53, v185
    v_mfma_f32_16x16x32_bf16 v[64:67], v[124:127], v[152:155], v[64:67]
    s_add_u32 m0, s47, 94208
    ds_read_b128 v[116:119], v10 offset:46080
    v_cvt_pk_bf16_f32 v182, v52, v53
    v_mfma_f32_16x16x32_bf16 v[68:71], v[124:127], v[156:159], v[68:71]
    s_waitcnt lgkmcnt(5)
    v_mul_f32 v60, v60, v62
    v_mul_f32 v61, v61, v63
    v_mfma_f32_16x16x32_bf16 v[72:75], v[96:99], v[152:155], v[72:75]
    ds_read_b128 v[120:123], v10 offset:47104
    v_fma_f32 v186, v186, s65, s65
    v_mfma_f32_16x16x32_bf16 v[76:79], v[96:99], v[156:159], v[76:79]
    s_waitcnt lgkmcnt(5)
    buffer_load_dwordx4 v243, s[4:7], m0 offen sc1 lds
    v_rcp_f32 v186, v186
    v_mfma_f32_16x16x32_bf16 v[80:83], v[100:103], v[152:155], v[80:83]
    ds_read_b128 v[124:127], v10 offset:48128
    v_fma_f32 v187, v187, s65, s65
    v_mfma_f32_16x16x32_bf16 v[84:87], v[100:103], v[156:159], v[84:87]
    s_waitcnt lgkmcnt(5)
    v_rcp_f32 v187, v187
    v_mfma_f32_16x16x32_bf16 v[64:67], v[104:107], v[160:163], v[64:67]
    ds_read_b128 v[96:99], v11 offset:0
    v_mul_f32 v60, v60, v186
    v_mfma_f32_16x16x32_bf16 v[68:71], v[104:107], v[164:167], v[68:71]
    s_waitcnt lgkmcnt(5)
    buffer_load_dwordx4 a[76:79], v1, s[4:7], s48 offen offset:3072 sc1
    v_mul_f32 v61, v61, v187
    v_mfma_f32_16x16x32_bf16 v[72:75], v[108:111], v[160:163], v[72:75]
    s_add_u32 s48, s49, 24576
    ds_read_b128 v[100:103], v11 offset:1024
    v_cvt_pk_bf16_f32 v183, v60, v61
    v_mfma_f32_16x16x32_bf16 v[76:79], v[108:111], v[164:167], v[76:79]
    s_waitcnt lgkmcnt(5)
    v_mfma_f32_16x16x32_bf16 v[80:83], v[112:115], v[160:163], v[80:83]
    ds_read_b128 v[104:107], v11 offset:2048
    v_mfma_f32_16x16x32_bf16 v[84:87], v[112:115], v[164:167], v[84:87]
    s_waitcnt lgkmcnt(5)
    buffer_store_dwordx4 v[180:183], v1, s[4:7], s46 offen offset:0 sc1
    v_mfma_f32_16x16x32_bf16 v[64:67], v[116:119], v[168:171], v[64:67]
    ds_read_b128 v[108:111], v11 offset:3072
    v_mfma_f32_16x16x32_bf16 v[68:71], v[116:119], v[172:175], v[68:71]
    s_waitcnt lgkmcnt(5)
    v_mfma_f32_16x16x32_bf16 v[72:75], v[120:123], v[168:171], v[72:75]
    ds_read_b128 v[112:115], v11 offset:4096
    v_mfma_f32_16x16x32_bf16 v[76:79], v[120:123], v[172:175], v[76:79]
    s_waitcnt lgkmcnt(5)
    buffer_load_dwordx4 a[96:99], v1, s[4:7], s48 offen offset:0 sc1
    v_mfma_f32_16x16x32_bf16 v[80:83], v[124:127], v[168:171], v[80:83]
    ds_read_b128 v[116:119], v11 offset:5120
    v_mfma_f32_16x16x32_bf16 v[84:87], v[124:127], v[172:175], v[84:87]
    s_waitcnt lgkmcnt(5)
    v_mfma_f32_16x16x32_bf16 v[32:35], v[96:99], a[176:179], 0
    ds_read_b128 v[120:123], v11 offset:6144
    v_mfma_f32_16x16x32_bf16 v[36:39], v[96:99], a[180:183], 0
    s_waitcnt lgkmcnt(5)
    buffer_load_dwordx2 v[246:247], v241, s[4:7], s77 offen sc1
    v_exp_f32 v184, -v64
    v_mfma_f32_16x16x32_bf16 v[40:43], v[100:103], a[176:179], 0
    ds_read_b128 v[124:127], v11 offset:7168
    v_mfma_f32_16x16x32_bf16 v[44:47], v[100:103], a[180:183], 0
    s_waitcnt lgkmcnt(5)
    v_mfma_f32_16x16x32_bf16 v[48:51], v[104:107], a[176:179], 0
    ds_read_b128 v[96:99], v11 offset:8192
    v_mul_f32 v64, v64, v66
    v_mfma_f32_16x16x32_bf16 v[52:55], v[104:107], a[180:183], 0
    s_waitcnt lgkmcnt(5)
    buffer_load_dwordx4 v[248:251], v1, s[4:7], s72 offen sc1
    v_exp_f32 v185, -v65
    v_mfma_f32_16x16x32_bf16 v[56:59], v[108:111], a[176:179], 0
    ds_read_b128 v[100:103], v11 offset:9216
    v_mul_f32 v65, v65, v67
    v_mfma_f32_16x16x32_bf16 v[60:63], v[108:111], a[180:183], 0
    s_waitcnt lgkmcnt(5)
    v_exp_f32 v186, -v72
    v_mfma_f32_16x16x32_bf16 v[32:35], v[112:115], a[184:187], v[32:35]
    ds_read_b128 v[104:107], v11 offset:10240
    v_fma_f32 v184, v184, s65, s65
    v_mfma_f32_16x16x32_bf16 v[36:39], v[112:115], a[188:191], v[36:39]
    s_waitcnt lgkmcnt(5)
    buffer_load_dwordx4 v[252:255], v1, s[4:7], s72 offen offset:1024 sc1
    v_rcp_f32 v184, v184
    v_mfma_f32_16x16x32_bf16 v[40:43], v[116:119], a[184:187], v[40:43]
    ds_read_b128 v[108:111], v11 offset:11264
    v_fma_f32 v185, v185, s65, s65
    v_mfma_f32_16x16x32_bf16 v[44:47], v[116:119], a[188:191], v[44:47]
    s_waitcnt lgkmcnt(5)
    v_rcp_f32 v185, v185
    v_mfma_f32_16x16x32_bf16 v[48:51], v[120:123], a[184:187], v[48:51]
    ds_read_b128 v[112:115], v11 offset:12288
    v_mul_f32 v64, v64, v184
    v_mfma_f32_16x16x32_bf16 v[52:55], v[120:123], a[188:191], v[52:55]
    s_waitcnt lgkmcnt(5)
    buffer_load_dwordx4 a[100:103], v1, s[4:7], s48 offen offset:1024 sc1
    v_exp_f32 v187, -v73
    v_mfma_f32_16x16x32_bf16 v[56:59], v[124:127], a[184:187], v[56:59]
    ds_read_b128 v[116:119], v11 offset:13312
    v_mul_f32 v65, v65, v185
    v_mfma_f32_16x16x32_bf16 v[60:63], v[124:127], a[188:191], v[60:63]
    s_waitcnt lgkmcnt(5)
    v_exp_f32 v188, -v80
    v_mfma_f32_16x16x32_bf16 v[32:35], v[96:99], a[192:195], v[32:35]
    ds_read_b128 v[120:123], v11 offset:14336
    v_cvt_pk_bf16_f32 v176, v64, v65
    v_mfma_f32_16x16x32_bf16 v[36:39], v[96:99], a[196:199], v[36:39]
    s_waitcnt lgkmcnt(5)
    buffer_load_dwordx4 a[104:107], v1, s[4:7], s48 offen offset:2048 sc1
    v_exp_f32 v189, -v81
    v_mfma_f32_16x16x32_bf16 v[40:43], v[100:103], a[192:195], v[40:43]
    ds_read_b128 v[124:127], v11 offset:15360
    v_mul_f32 v72, v72, v74
    v_mfma_f32_16x16x32_bf16 v[44:47], v[100:103], a[196:199], v[44:47]
    s_waitcnt lgkmcnt(5)
    v_exp_f32 v184, -v68
    v_mfma_f32_16x16x32_bf16 v[48:51], v[104:107], a[192:195], v[48:51]
    ds_read_b128 v[96:99], v11 offset:16384
    v_mul_f32 v73, v73, v75
    v_mfma_f32_16x16x32_bf16 v[52:55], v[104:107], a[196:199], v[52:55]
    s_waitcnt lgkmcnt(5)
    buffer_load_dwordx4 a[108:111], v1, s[4:7], s48 offen offset:3072 sc1
    v_exp_f32 v185, -v69
    v_mfma_f32_16x16x32_bf16 v[56:59], v[108:111], a[192:195], v[56:59]
    s_add_u32 s48, s49, 32768
    ds_read_b128 v[100:103], v11 offset:17408
    v_fma_f32 v186, v186, s65, s65
    v_mfma_f32_16x16x32_bf16 v[60:63], v[108:111], a[196:199], v[60:63]
    s_waitcnt lgkmcnt(5)
    v_rcp_f32 v186, v186
    v_mfma_f32_16x16x32_bf16 v[32:35], v[112:115], a[200:203], v[32:35]
    ds_read_b128 v[104:107], v11 offset:18432
    v_fma_f32 v187, v187, s65, s65
    v_mfma_f32_16x16x32_bf16 v[36:39], v[112:115], a[204:207], v[36:39]
    s_waitcnt lgkmcnt(5)
    buffer_load_dwordx4 a[128:131], v1, s[4:7], s48 offen offset:0 sc1
    v_rcp_f32 v187, v187
    v_mfma_f32_16x16x32_bf16 v[40:43], v[116:119], a[200:203], v[40:43]
    ds_read_b128 v[108:111], v11 offset:19456
    v_mul_f32 v72, v72, v186
    v_mfma_f32_16x16x32_bf16 v[44:47], v[116:119], a[204:207], v[44:47]
    s_waitcnt lgkmcnt(5)
    s_waitcnt vmcnt(8)
    s_mov_b64 exec, s[60:61]
    buffer_store_dword v30, off, s[4:7], s74 offset:4
    s_mov_b64 exec, s[62:63]
    buffer_store_dword v30, off, s[4:7], s74 offset:4 sc1
    s_mov_b64 exec, -1
    v_mul_f32 v73, v73, v187
    v_mul_f32 v80, v80, v82
    v_mfma_f32_16x16x32_bf16 v[48:51], v[120:123], a[200:203], v[48:51]
    ds_read_b128 v[112:115], v11 offset:20480
    v_cvt_pk_bf16_f32 v177, v72, v73
    v_mfma_f32_16x16x32_bf16 v[52:55], v[120:123], a[204:207], v[52:55]
    s_waitcnt lgkmcnt(5)
    buffer_load_dwordx4 a[132:135], v1, s[4:7], s48 offen offset:1024 sc1
    v_exp_f32 v186, -v76
    v_mfma_f32_16x16x32_bf16 v[56:59], v[124:127], a[200:203], v[56:59]
    ds_read_b128 v[116:119], v11 offset:21504
    v_mul_f32 v81, v81, v83
    v_mfma_f32_16x16x32_bf16 v[60:63], v[124:127], a[204:207], v[60:63]
    s_waitcnt lgkmcnt(5)
    v_exp_f32 v187, -v77
    v_mfma_f32_16x16x32_bf16 v[32:35], v[96:99], a[208:211], v[32:35]
    ds_read_b128 v[120:123], v11 offset:22528
    v_fma_f32 v188, v188, s65, s65
    v_mfma_f32_16x16x32_bf16 v[36:39], v[96:99], a[212:215], v[36:39]
    s_waitcnt lgkmcnt(5)
    buffer_load_dwordx4 a[136:139], v1, s[4:7], s48 offen offset:2048 sc1
    v_rcp_f32 v188, v188
    v_mfma_f32_16x16x32_bf16 v[40:43], v[100:103], a[208:211], v[40:43]
    ds_read_b128 v[124:127], v11 offset:23552
    v_fma_f32 v189, v189, s65, s65
    v_mfma_f32_16x16x32_bf16 v[44:47], v[100:103], a[212:215], v[44:47]
    s_waitcnt lgkmcnt(5)
    v_rcp_f32 v189, v189
    v_mfma_f32_16x16x32_bf16 v[48:51], v[104:107], a[208:211], v[48:51]
    ds_read_b128 v[96:99], v11 offset:24576
    v_mul_f32 v80, v80, v188
    v_mfma_f32_16x16x32_bf16 v[52:55], v[104:107], a[212:215], v[52:55]
    s_waitcnt lgkmcnt(5)
    buffer_load_dwordx4 a[140:143], v1, s[4:7], s48 offen offset:3072 sc1
    v_mul_f32 v81, v81, v189
    v_mfma_f32_16x16x32_bf16 v[56:59], v[108:111], a[208:211], v[56:59]
    s_add_u32 s48, s49, 36864
    ds_read_b128 v[100:103], v11 offset:25600
    v_cvt_pk_bf16_f32 v178, v80, v81
    v_mfma_f32_16x16x32_bf16 v[60:63], v[108:111], a[212:215], v[60:63]
    s_waitcnt lgkmcnt(5)
    v_permlane32_swap_b32 v176, v178
    v_mfma_f32_16x16x32_bf16 v[32:35], v[112:115], a[216:219], v[32:35]
    ds_read_b128 v[104:107], v11 offset:26624
    v_mul_f32 v68, v68, v70
    v_mfma_f32_16x16x32_bf16 v[36:39], v[112:115], a[220:223], v[36:39]
    s_waitcnt lgkmcnt(5)
    buffer_load_dwordx4 a[144:147], v1, s[4:7], s48 offen offset:0 sc1
    v_permlane32_swap_b32 v177, v179
    v_mfma_f32_16x16x32_bf16 v[40:43], v[116:119], a[216:219], v[40:43]
    ds_read_b128 v[108:111], v11 offset:27648
    v_mul_f32 v69, v69, v71
    v_mfma_f32_16x16x32_bf16 v[44:47], v[116:119], a[220:223], v[44:47]
    s_waitcnt lgkmcnt(5)
    v_permlane16_swap_b32 v176, v177
    v_mfma_f32_16x16x32_bf16 v[48:51], v[120:123], a[216:219], v[48:51]
    ds_read_b128 v[112:115], v11 offset:28672
    v_fma_f32 v184, v184, s65, s65
    v_mfma_f32_16x16x32_bf16 v[52:55], v[120:123], a[220:223], v[52:55]
    s_waitcnt lgkmcnt(5)
    buffer_load_dwordx4 a[148:151], v1, s[4:7], s48 offen offset:1024 sc1
    v_permlane16_swap_b32 v178, v179
    v_mfma_f32_16x16x32_bf16 v[56:59], v[124:127], a[216:219], v[56:59]
    ds_read_b128 v[116:119], v11 offset:29696
    v_fma_f32 v185, v185, s65, s65
    v_mfma_f32_16x16x32_bf16 v[60:63], v[124:127], a[220:223], v[60:63]
    s_waitcnt lgkmcnt(5)
    v_rcp_f32 v184, v184
    v_mfma_f32_16x16x32_bf16 v[32:35], v[96:99], a[224:227], v[32:35]
    ds_read_b128 v[120:123], v11 offset:30720
    v_mul_f32 v68, v68, v184
    v_mfma_f32_16x16x32_bf16 v[36:39], v[96:99], a[228:231], v[36:39]
    s_waitcnt lgkmcnt(5)
    buffer_load_dwordx4 a[152:155], v1, s[4:7], s48 offen offset:2048 sc1
    v_rcp_f32 v185, v185
    v_mfma_f32_16x16x32_bf16 v[40:43], v[100:103], a[224:227], v[40:43]
    ds_read_b128 v[124:127], v11 offset:31744
    v_mul_f32 v69, v69, v185
    v_mfma_f32_16x16x32_bf16 v[44:47], v[100:103], a[228:231], v[44:47]
    s_waitcnt lgkmcnt(5)
    v_exp_f32 v188, -v84
    v_mfma_f32_16x16x32_bf16 v[48:51], v[104:107], a[224:227], v[48:51]
    ds_read_b128 v[96:99], v11 offset:32768
    v_cvt_pk_bf16_f32 v180, v68, v69
    v_mfma_f32_16x16x32_bf16 v[52:55], v[104:107], a[228:231], v[52:55]
    s_waitcnt lgkmcnt(5)
    buffer_load_dwordx4 a[156:159], v1, s[4:7], s48 offen offset:3072 sc1
    v_exp_f32 v189, -v85
    v_mfma_f32_16x16x32_bf16 v[56:59], v[108:111], a[224:227], v[56:59]
    s_add_u32 s48, s49, 40960
    ds_read_b128 v[100:103], v11 offset:33792
    v_mul_f32 v76, v76, v78
    v_mfma_f32_16x16x32_bf16 v[60:63], v[108:111], a[228:231], v[60:63]
    s_waitcnt lgkmcnt(5)
    v_mul_f32 v77, v77, v79
    v_fma_f32 v186, v186, s65, s65
    v_mfma_f32_16x16x32_bf16 v[32:35], v[112:115], a[232:235], v[32:35]
    ds_read_b128 v[104:107], v11 offset:34816
    v_fma_f32 v187, v187, s65, s65
    v_mfma_f32_16x16x32_bf16 v[36:39], v[112:115], a[236:239], v[36:39]
    s_waitcnt lgkmcnt(5)
    buffer_load_dwordx4 a[160:163], v1, s[4:7], s48 offen offset:0 sc1
    v_rcp_f32 v186, v186
    v_mfma_f32_16x16x32_bf16 v[40:43], v[116:119], a[232:235], v[40:43]
    ds_read_b128 v[108:111], v11 offset:35840
    v_mul_f32 v76, v76, v186
    v_mfma_f32_16x16x32_bf16 v[44:47], v[116:119], a[236:239], v[44:47]
    s_waitcnt lgkmcnt(5)
    v_rcp_f32 v187, v187
    v_mfma_f32_16x16x32_bf16 v[48:51], v[120:123], a[232:235], v[48:51]
    ds_read_b128 v[112:115], v11 offset:36864
    v_mul_f32 v77, v77, v187
    v_mfma_f32_16x16x32_bf16 v[52:55], v[120:123], a[236:239], v[52:55]
    s_waitcnt lgkmcnt(5)
    buffer_load_dwordx4 a[164:167], v1, s[4:7], s48 offen offset:1024 sc1
    v_cvt_pk_bf16_f32 v181, v76, v77
    v_mfma_f32_16x16x32_bf16 v[56:59], v[124:127], a[232:235], v[56:59]
    ds_read_b128 v[116:119], v11 offset:37888
    v_mul_f32 v84, v84, v86
    v_mfma_f32_16x16x32_bf16 v[60:63], v[124:127], a[236:239], v[60:63]
    s_waitcnt lgkmcnt(5)
    v_mul_f32 v85, v85, v87
    v_fma_f32 v188, v188, s65, s65
    v_mfma_f32_16x16x32_bf16 v[32:35], v[96:99], a[240:243], v[32:35]
    ds_read_b128 v[120:123], v11 offset:38912
    v_fma_f32 v189, v189, s65, s65
    v_mfma_f32_16x16x32_bf16 v[36:39], v[96:99], a[244:247], v[36:39]
    s_waitcnt lgkmcnt(5)
    buffer_load_dword v240, v239, s[4:7], s76 offen offset:4 sc1
    v_rcp_f32 v188, v188
    v_mfma_f32_16x16x32_bf16 v[40:43], v[100:103], a[240:243], v[40:43]
    ds_read_b128 v[124:127], v11 offset:39936
    v_mul_f32 v84, v84, v188
    v_mfma_f32_16x16x32_bf16 v[44:47], v[100:103], a[244:247], v[44:47]
    s_waitcnt lgkmcnt(5)
    v_rcp_f32 v189, v189
    v_mfma_f32_16x16x32_bf16 v[48:51], v[104:107], a[240:243], v[48:51]
    ds_read_b128 v[96:99], v11 offset:40960
    v_mul_f32 v85, v85, v189
    v_mfma_f32_16x16x32_bf16 v[52:55], v[104:107], a[244:247], v[52:55]
    s_waitcnt lgkmcnt(5)
    buffer_load_dwordx4 a[168:171], v1, s[4:7], s48 offen offset:2048 sc1
    v_cvt_pk_bf16_f32 v182, v84, v85
    v_mfma_f32_16x16x32_bf16 v[56:59], v[108:111], a[240:243], v[56:59]
    ds_read_b128 v[100:103], v11 offset:41984
    v_mfma_f32_16x16x32_bf16 v[60:63], v[108:111], a[244:247], v[60:63]
    s_waitcnt lgkmcnt(5)
    v_permlane32_swap_b32 v180, v182
    v_mfma_f32_16x16x32_bf16 v[32:35], v[112:115], a[248:251], v[32:35]
    ds_read_b128 v[104:107], v11 offset:43008
    v_mfma_f32_16x16x32_bf16 v[36:39], v[112:115], a[252:255], v[36:39]
    s_waitcnt lgkmcnt(5)
    buffer_load_dwordx4 a[172:175], v1, s[4:7], s48 offen offset:3072 sc1
    v_permlane32_swap_b32 v181, v183
    v_mfma_f32_16x16x32_bf16 v[40:43], v[116:119], a[248:251], v[40:43]
    s_add_u32 s48, s49, 4096
    ds_read_b128 v[108:111], v11 offset:44032
    v_mfma_f32_16x16x32_bf16 v[44:47], v[116:119], a[252:255], v[44:47]
    s_waitcnt lgkmcnt(5)
    v_permlane16_swap_b32 v180, v181
    v_mfma_f32_16x16x32_bf16 v[48:51], v[120:123], a[248:251], v[48:51]
    ds_read_b128 v[112:115], v11 offset:45056
    v_mfma_f32_16x16x32_bf16 v[52:55], v[120:123], a[252:255], v[52:55]
    s_waitcnt lgkmcnt(5)
    buffer_load_dwordx4 a[16:19], v1, s[4:7], s48 offen offset:0 sc1
    v_permlane16_swap_b32 v182, v183
    v_mfma_f32_16x16x32_bf16 v[56:59], v[124:127], a[248:251], v[56:59]
    ds_read_b128 v[116:119], v11 offset:46080
    v_mfma_f32_16x16x32_bf16 v[60:63], v[124:127], a[252:255], v[60:63]
    s_waitcnt lgkmcnt(5)
    v_mfma_f32_16x16x32_bf16 v[32:35], v[96:99], v[128:131], v[32:35]
    ds_read_b128 v[120:123], v11 offset:47104
    v_mfma_f32_16x16x32_bf16 v[36:39], v[96:99], v[132:135], v[36:39]
    s_waitcnt lgkmcnt(5)
    s_mov_b32 exec_hi, 0xffff
    buffer_store_dwordx4 v[176:179], v1, s[4:7], s78 offen offset:2048 sc1
    s_mov_b32 exec_hi, -1
    v_mfma_f32_16x16x32_bf16 v[40:43], v[100:103], v[128:131], v[40:43]
    ds_read_b128 v[124:127], v11 offset:48128
    v_mfma_f32_16x16x32_bf16 v[44:47], v[100:103], v[132:135], v[44:47]
    s_waitcnt vmcnt(25) lgkmcnt(5)
    s_barrier
    v_mfma_f32_16x16x32_bf16 v[48:51], v[104:107], v[128:131], v[48:51]
    ds_read_b128 v[96:99], v10 offset:16384
    v_mfma_f32_16x16x32_bf16 v[52:55], v[104:107], v[132:135], v[52:55]
    s_waitcnt lgkmcnt(5)
    s_mov_b32 exec_hi, 0xffff
    buffer_store_dwordx4 v[180:183], v1, s[4:7], s46 offen offset:2048 sc1
    s_mov_b32 exec_hi, -1
    v_mfma_f32_16x16x32_bf16 v[56:59], v[108:111], v[128:131], v[56:59]
    ds_read_b128 v[100:103], v10 offset:17408
    v_mfma_f32_16x16x32_bf16 v[60:63], v[108:111], v[132:135], v[60:63]
    s_waitcnt lgkmcnt(5)
    v_mfma_f32_16x16x32_bf16 v[32:35], v[112:115], v[136:139], v[32:35]
    ds_read_b128 v[104:107], v10 offset:18432
    v_mfma_f32_16x16x32_bf16 v[36:39], v[112:115], v[140:143], v[36:39]
    s_waitcnt lgkmcnt(5)
    buffer_load_dwordx4 a[20:23], v1, s[4:7], s48 offen offset:1024 sc1
    v_mfma_f32_16x16x32_bf16 v[40:43], v[116:119], v[136:139], v[40:43]
    ds_read_b128 v[108:111], v10 offset:19456
    v_mfma_f32_16x16x32_bf16 v[44:47], v[116:119], v[140:143], v[44:47]
    s_waitcnt lgkmcnt(5)
    v_mfma_f32_16x16x32_bf16 v[48:51], v[120:123], v[136:139], v[48:51]
    ds_read_b128 v[112:115], v10 offset:20480
    v_mfma_f32_16x16x32_bf16 v[52:55], v[120:123], v[140:143], v[52:55]
    s_waitcnt lgkmcnt(5)
    buffer_load_dwordx4 a[24:27], v1, s[4:7], s48 offen offset:2048 sc1
    v_mfma_f32_16x16x32_bf16 v[56:59], v[124:127], v[136:139], v[56:59]
    ds_read_b128 v[116:119], v10 offset:21504
    v_mfma_f32_16x16x32_bf16 v[60:63], v[124:127], v[140:143], v[60:63]
    s_waitcnt lgkmcnt(5)
    s_waitcnt vmcnt(7)
    v_cmp_ne_u32 vcc, s28, v240
    s_cbranch_vccnz L_pA0_re
L_pA0_ok:
    buffer_load_dwordx4 a[28:31], v1, s[4:7], s48 offen offset:3072 sc1
    v_lshlrev_b32 v64, 16, v248
    v_mfma_f32_16x16x32_bf16 v[32:35], v[96:99], v[144:147], v[32:35]
    s_add_u32 s48, s49, 12288
    ds_read_b128 v[120:123], v10 offset:22528
    v_and_b32 v65, 0xffff0000, v248
    v_mfma_f32_16x16x32_bf16 v[36:39], v[96:99], v[148:151], v[36:39]
    s_waitcnt lgkmcnt(5)
    buffer_load_dwordx4 a[48:51], v1, s[4:7], s48 offen offset:0 sc1
    v_fma_f32 v64, v64, v246, v247
    v_mfma_f32_16x16x32_bf16 v[40:43], v[100:103], v[144:147], v[40:43]
    ds_read_b128 v[124:127], v10 offset:23552
    v_fma_f32 v65, v65, v246, v247
    v_mfma_f32_16x16x32_bf16 v[44:47], v[100:103], v[148:151], v[44:47]
    s_waitcnt lgkmcnt(5)
    buffer_load_dwordx4 a[52:55], v1, s[4:7], s48 offen offset:1024 sc1
    v_lshlrev_b32 v66, 16, v249
    v_mfma_f32_16x16x32_bf16 v[48:51], v[104:107], v[144:147], v[48:51]
    ds_read_b128 v[96:99], v10 offset:24576
    v_and_b32 v67, 0xffff0000, v249
    v_mfma_f32_16x16x32_bf16 v[52:55], v[104:107], v[148:151], v[52:55]
    s_waitcnt lgkmcnt(5)
    buffer_load_dwordx4 a[56:59], v1, s[4:7], s48 offen offset:2048 sc1
    v_fma_f32 v66, v66, v246, v247
    v_mfma_f32_16x16x32_bf16 v[56:59], v[108:111], v[144:147], v[56:59]
    ds_read_b128 v[100:103], v10 offset:25600
    v_fma_f32 v67, v67, v246, v247
    v_mfma_f32_16x16x32_bf16 v[60:63], v[108:111], v[148:151], v[60:63]
    s_waitcnt lgkmcnt(5)
    buffer_load_dwordx4 a[60:63], v1, s[4:7], s48 offen offset:3072 sc1
    v_lshlrev_b32 v68, 16, v250
    v_mfma_f32_16x16x32_bf16 v[32:35], v[112:115], v[152:155], v[32:35]
    ds_read_b128 v[104:107], v10 offset:26624
    v_and_b32 v69, 0xffff0000, v250
    v_mfma_f32_16x16x32_bf16 v[36:39], v[112:115], v[156:159], v[36:39]
    s_waitcnt lgkmcnt(5)
    buffer_load_dwordx4 v[192:195], v1, s[4:7], s96 offen offset:0 sc1
    v_fma_f32 v68, v68, v246, v247
    v_mfma_f32_16x16x32_bf16 v[40:43], v[116:119], v[152:155], v[40:43]
    ds_read_b128 v[108:111], v10 offset:27648
    v_fma_f32 v69, v69, v246, v247
    v_mfma_f32_16x16x32_bf16 v[44:47], v[116:119], v[156:159], v[44:47]
    s_waitcnt lgkmcnt(5)
    buffer_load_dwordx4 v[196:199], v1, s[4:7], s97 offen offset:0 sc1
    v_lshlrev_b32 v70, 16, v251
    v_mfma_f32_16x16x32_bf16 v[48:51], v[120:123], v[152:155], v[48:51]
    ds_read_b128 v[112:115], v10 offset:28672
    v_and_b32 v71, 0xffff0000, v251
    v_mfma_f32_16x16x32_bf16 v[52:55], v[120:123], v[156:159], v[52:55]
    s_waitcnt lgkmcnt(5)
    v_fma_f32 v70, v70, v246, v247
    v_fma_f32 v71, v71, v246, v247
    v_mfma_f32_16x16x32_bf16 v[56:59], v[124:127], v[152:155], v[56:59]
    ds_read_b128 v[116:119], v10 offset:29696
    v_lshlrev_b32 v72, 16, v252
    v_mfma_f32_16x16x32_bf16 v[60:63], v[124:127], v[156:159], v[60:63]
    s_waitcnt lgkmcnt(5)
    buffer_load_dwordx4 v[200:203], v1, s[4:7], s98 offen offset:0 sc1
    v_and_b32 v73, 0xffff0000, v252
    v_mfma_f32_16x16x32_bf16 v[32:35], v[96:99], v[160:163], v[32:35]
    ds_read_b128 v[120:123], v10 offset:30720
    v_fma_f32 v72, v72, v246, v247
    v_mfma_f32_16x16x32_bf16 v[36:39], v[96:99], v[164:167], v[36:39]
    s_waitcnt lgkmcnt(5)
    v_fma_f32 v73, v73, v246, v247
    v_lshlrev_b32 v74, 16, v253
    v_mfma_f32_16x16x32_bf16 v[40:43], v[100:103], v[160:163], v[40:43]
    ds_read_b128 v[124:127], v10 offset:31744
    v_and_b32 v75, 0xffff0000, v253
    v_mfma_f32_16x16x32_bf16 v[44:47], v[100:103], v[164:167], v[44:47]
    s_waitcnt lgkmcnt(5)
    buffer_load_dwordx4 v[204:207], v1, s[4:7], s99 offen offset:0 sc1
    v_fma_f32 v74, v74, v246, v247
    v_mfma_f32_16x16x32_bf16 v[48:51], v[104:107], v[160:163], v[48:51]
    s_add_u32 s96, s96, s84
    v_fma_f32 v75, v75, v246, v247
    v_mfma_f32_16x16x32_bf16 v[52:55], v[104:107], v[164:167], v[52:55]
    s_waitcnt lgkmcnt(4)
    v_lshlrev_b32 v76, 16, v254
    v_and_b32 v77, 0xffff0000, v254
    v_mfma_f32_16x16x32_bf16 v[56:59], v[108:111], v[160:163], v[56:59]
    v_fma_f32 v76, v76, v246, v247
    v_mfma_f32_16x16x32_bf16 v[60:63], v[108:111], v[164:167], v[60:63]
    s_waitcnt lgkmcnt(3)
    buffer_load_dwordx4 v[208:211], v1, s[4:7], s96 offen offset:0 sc1
    v_fma_f32 v77, v77, v246, v247
    v_mfma_f32_16x16x32_bf16 v[32:35], v[112:115], v[168:171], v[32:35]
    s_add_u32 s97, s97, s84
    v_lshlrev_b32 v78, 16, v255
    v_mfma_f32_16x16x32_bf16 v[36:39], v[112:115], v[172:175], v[36:39]
    s_waitcnt lgkmcnt(2)
    v_and_b32 v79, 0xffff0000, v255
    v_fma_f32 v78, v78, v246, v247
    v_mfma_f32_16x16x32_bf16 v[40:43], v[116:119], v[168:171], v[40:43]
    v_fma_f32 v79, v79, v246, v247
    v_mfma_f32_16x16x32_bf16 v[44:47], v[116:119], v[172:175], v[44:47]
    s_waitcnt lgkmcnt(1)
    buffer_load_dwordx4 v[212:215], v1, s[4:7], s97 offen offset:0 sc1
    v_mfma_f32_16x16x32_bf16 v[48:51], v[120:123], v[168:171], v[48:51]
    s_add_u32 s98, s98, s84
    v_mfma_f32_16x16x32_bf16 v[52:55], v[120:123], v[172:175], v[52:55]
    s_waitcnt lgkmcnt(0)
    v_mfma_f32_16x16x32_bf16 v[56:59], v[124:127], v[168:171], v[56:59]
    v_mfma_f32_16x16x32_bf16 v[60:63], v[124:127], v[172:175], v[60:63]
    buffer_load_dwordx4 v[216:219], v1, s[4:7], s98 offen offset:0 sc1
    v_exp_f32 v184, -v32
    v_exp_f32 v185, -v33
    v_exp_f32 v186, -v40
    v_pk_mul_f32 v[32:33], v[32:33], v[34:35]
    v_exp_f32 v187, -v41
    v_pk_fma_f32 v[184:185], v[184:185], s[30:31], s[30:31]
    v_rcp_f32 v184, v184
    v_pk_mul_f32 v[40:41], v[40:41], v[42:43]
    v_rcp_f32 v185, v185
    v_pk_fma_f32 v[186:187], v[186:187], s[30:31], s[30:31]
    v_rcp_f32 v186, v186
    v_pk_mul_f32 v[32:33], v[32:33], v[184:185]
    v_rcp_f32 v187, v187
    v_cvt_pk_bf16_f32 v176, v32, v33
    v_exp_f32 v188, -v48
    v_pk_mul_f32 v[40:41], v[40:41], v[186:187]
    v_exp_f32 v189, -v49
    v_cvt_pk_bf16_f32 v177, v40, v41
    v_exp_f32 v184, -v56
    v_pk_mul_f32 v[48:49], v[48:49], v[50:51]
    v_exp_f32 v185, -v57
    v_pk_fma_f32 v[188:189], v[188:189], s[30:31], s[30:31]
    v_rcp_f32 v188, v188
    v_pk_mul_f32 v[56:57], v[56:57], v[58:59]
    v_rcp_f32 v189, v189
    v_pk_fma_f32 v[184:185], v[184:185], s[30:31], s[30:31]
    v_rcp_f32 v184, v184
    v_pk_mul_f32 v[48:49], v[48:49], v[188:189]
    s_waitcnt vmcnt(14)
    s_mov_b64 exec, s[60:61]
    buffer_store_dword v30, off, s[4:7], s74 offset:8
    s_mov_b64 exec, s[62:63]
    buffer_store_dword v30, off, s[4:7], s74 offset:8 sc1
    s_mov_b64 exec, -1
    v_rcp_f32 v185, v185
    v_cvt_pk_bf16_f32 v178, v48, v49
    s_add_u32 s99, s99, s84
    buffer_load_dwordx4 v[220:223], v1, s[4:7], s99 offen offset:0 sc1
    v_exp_f32 v186, -v36
    v_pk_mul_f32 v[56:57], v[56:57], v[184:185]
    v_exp_f32 v187, -v37
    v_cvt_pk_bf16_f32 v179, v56, v57
    v_exp_f32 v188, -v44
    v_pk_mul_f32 v[36:37], v[36:37], v[38:39]
    v_exp_f32 v189, -v45
    v_pk_fma_f32 v[186:187], v[186:187], s[30:31], s[30:31]
    v_rcp_f32 v186, v186
    v_pk_mul_f32 v[44:45], v[44:45], v[46:47]
    s_add_u32 s96, s96, s85
    buffer_load_dwordx4 v[224:227], v1, s[4:7], s96 offen offset:0 sc1
    v_rcp_f32 v187, v187
    v_pk_fma_f32 v[188:189], v[188:189], s[30:31], s[30:31]
    v_rcp_f32 v188, v188
    v_pk_mul_f32 v[36:37], v[36:37], v[186:187]
    v_rcp_f32 v189, v189
    v_cvt_pk_bf16_f32 v180, v36, v37
    v_exp_f32 v184, -v52
    v_pk_mul_f32 v[44:45], v[44:45], v[188:189]
    v_exp_f32 v185, -v53
    v_cvt_pk_bf16_f32 v181, v44, v45
    s_add_u32 s97, s97, s85
    buffer_load_dwordx4 v[228:231], v1, s[4:7], s97 offen offset:0 sc1
    v_exp_f32 v186, -v60
    v_pk_mul_f32 v[52:53], v[52:53], v[54:55]
    v_exp_f32 v187, -v61
    v_pk_fma_f32 v[184:185], v[184:185], s[30:31], s[30:31]
    v_rcp_f32 v184, v184
    v_pk_mul_f32 v[60:61], v[60:61], v[62:63]
    v_rcp_f32 v185, v185
    v_pk_fma_f32 v[186:187], v[186:187], s[30:31], s[30:31]
    v_rcp_f32 v186, v186
    v_pk_mul_f32 v[52:53], v[52:53], v[184:185]
    s_add_u32 s98, s98, s85
    buffer_load_dwordx4 v[232:235], v1, s[4:7], s98 offen offset:0 sc1
    v_rcp_f32 v187, v187
    v_cvt_pk_bf16_f32 v182, v52, v53
    v_pk_mul_f32 v[60:61], v[60:61], v[186:187]
    v_cvt_pk_bf16_f32 v183, v60, v61
    buffer_load_dword v240, v239, s[4:7], s76 offen offset:8 sc1
    buffer_store_dwordx4 v[176:179], v1, s[4:7], s78 offen offset:1024 sc1
    buffer_store_dwordx4 v[180:183], v1, s[4:7], s46 offen offset:1024 sc1
    s_add_u32 s99, s99, s85
    buffer_load_dwordx4 v[160:163], v1, s[4:7], s99 offen offset:0 sc1
    s_waitcnt vmcnt(15)
    v_mfma_f32_16x16x32_bf16 v[32:35], a[0:3], v[192:195], 0
    s_add_u32 s96, s96, s86
    buffer_load_dwordx4 v[164:167], v1, s[4:7], s96 offen offset:0 sc1
    v_mfma_f32_16x16x32_bf16 v[36:39], a[4:7], v[192:195], 0
    s_add_u32 s97, s97, s86
    v_mfma_f32_16x16x32_bf16 v[40:43], a[8:11], v[192:195], 0
    v_mfma_f32_16x16x32_bf16 v[44:47], a[12:15], v[192:195], 0
    s_waitcnt vmcnt(15)
    v_mfma_f32_16x16x32_bf16 v[48:51], a[0:3], v[196:199], 0
    buffer_load_dwordx4 v[168:171], v1, s[4:7], s97 offen offset:0 sc1
    v_mfma_f32_16x16x32_bf16 v[52:55], a[4:7], v[196:199], 0
    s_add_u32 s98, s98, s86
    v_mfma_f32_16x16x32_bf16 v[56:59], a[8:11], v[196:199], 0
    v_mfma_f32_16x16x32_bf16 v[60:63], a[12:15], v[196:199], 0
    s_waitcnt vmcnt(15)
    v_mfma_f32_16x16x32_bf16 v[80:83], a[0:3], v[200:203], 0
    buffer_load_dwordx4 v[172:175], v1, s[4:7], s98 offen offset:0 sc1
    v_mfma_f32_16x16x32_bf16 v[84:87], a[4:7], v[200:203], 0
    s_add_u32 s99, s99, s86
    v_mfma_f32_16x16x32_bf16 v[88:91], a[8:11], v[200:203], 0
    v_mfma_f32_16x16x32_bf16 v[92:95], a[12:15], v[200:203], 0
    s_waitcnt vmcnt(15)
    v_mfma_f32_16x16x32_bf16 v[64:67], a[0:3], v[204:207], v[64:67]
    buffer_load_dwordx4 v[96:99], v1, s[4:7], s99 offen offset:0 sc1
    v_mfma_f32_16x16x32_bf16 v[68:71], a[4:7], v[204:207], v[68:71]
    s_sub_u32 s96, s96, s87
    v_mfma_f32_16x16x32_bf16 v[72:75], a[8:11], v[204:207], v[72:75]
    s_add_u32 s48, s49, 20480
    buffer_load_dwordx4 a[80:83], v1, s[4:7], s48 offen offset:0 sc1
    v_mfma_f32_16x16x32_bf16 v[76:79], a[12:15], v[204:207], v[76:79]
    s_waitcnt vmcnt(16)
    v_mfma_f32_16x16x32_bf16 v[32:35], a[32:35], v[208:211], v[32:35]
    buffer_load_dwordx4 a[84:87], v1, s[4:7], s48 offen offset:1024 sc1
    v_mfma_f32_16x16x32_bf16 v[36:39], a[36:39], v[208:211], v[36:39]
    v_mfma_f32_16x16x32_bf16 v[40:43], a[40:43], v[208:211], v[40:43]
    buffer_load_dwordx4 a[88:91], v1, s[4:7], s48 offen offset:2048 sc1
    v_mfma_f32_16x16x32_bf16 v[44:47], a[44:47], v[208:211], v[44:47]
    s_waitcnt vmcnt(17)
    v_mfma_f32_16x16x32_bf16 v[48:51], a[32:35], v[212:215], v[48:51]
    buffer_load_dwordx4 a[92:95], v1, s[4:7], s48 offen offset:3072 sc1
    v_mfma_f32_16x16x32_bf16 v[52:55], a[36:39], v[212:215], v[52:55]
    v_mfma_f32_16x16x32_bf16 v[56:59], a[40:43], v[212:215], v[56:59]
    s_add_u32 s48, s49, 28672
    buffer_load_dwordx4 a[112:115], v1, s[4:7], s48 offen offset:0 sc1
    v_mfma_f32_16x16x32_bf16 v[60:63], a[44:47], v[212:215], v[60:63]
    s_waitcnt vmcnt(18)
    v_mfma_f32_16x16x32_bf16 v[80:83], a[32:35], v[216:219], v[80:83]
    buffer_load_dwordx4 a[116:119], v1, s[4:7], s48 offen offset:1024 sc1
    v_mfma_f32_16x16x32_bf16 v[84:87], a[36:39], v[216:219], v[84:87]
    v_mfma_f32_16x16x32_bf16 v[88:91], a[40:43], v[216:219], v[88:91]
    buffer_load_dwordx4 a[120:123], v1, s[4:7], s48 offen offset:2048 sc1
    v_mfma_f32_16x16x32_bf16 v[92:95], a[44:47], v[216:219], v[92:95]
    s_waitcnt vmcnt(18)
    v_mfma_f32_16x16x32_bf16 v[64:67], a[32:35], v[220:223], v[64:67]
    buffer_load_dwordx4 a[124:127], v1, s[4:7], s48 offen offset:3072 sc1
    v_mfma_f32_16x16x32_bf16 v[68:71], a[36:39], v[220:223], v[68:71]
    v_mfma_f32_16x16x32_bf16 v[72:75], a[40:43], v[220:223], v[72:75]
    v_mfma_f32_16x16x32_bf16 v[76:79], a[44:47], v[220:223], v[76:79]
    s_waitcnt vmcnt(18)
    v_mfma_f32_16x16x32_bf16 v[32:35], a[64:67], v[224:227], v[32:35]
    v_mfma_f32_16x16x32_bf16 v[36:39], a[68:71], v[224:227], v[36:39]
    v_mfma_f32_16x16x32_bf16 v[40:43], a[72:75], v[224:227], v[40:43]
    v_mfma_f32_16x16x32_bf16 v[44:47], a[76:79], v[224:227], v[44:47]
    s_waitcnt vmcnt(17)
    v_mfma_f32_16x16x32_bf16 v[48:51], a[64:67], v[228:231], v[48:51]
    v_mfma_f32_16x16x32_bf16 v[52:55], a[68:71], v[228:231], v[52:55]
    v_mfma_f32_16x16x32_bf16 v[56:59], a[72:75], v[228:231], v[56:59]
    v_mfma_f32_16x16x32_bf16 v[60:63], a[76:79], v[228:231], v[60:63]
    s_waitcnt vmcnt(16)
    v_mfma_f32_16x16x32_bf16 v[80:83], a[64:67], v[232:235], v[80:83]
    s_waitcnt vmcnt(15)
    v_cmp_ne_u32 vcc, s28, v240
    s_cbranch_vccnz L_pR0_re
L_pR0_ok:
    buffer_load_dwordx4 a[176:179], v24, s[4:7], s96 offen offset:2048 sc1
    s_sub_u32 s97, s97, s87
    buffer_load_dwordx4 a[180:183], v24, s[4:7], s97 offen offset:2048 sc1
    s_sub_u32 s98, s98, s87
    buffer_load_dwordx4 a[184:187], v24, s[4:7], s98 offen offset:2048 sc1
    v_mfma_f32_16x16x32_bf16 v[84:87], a[68:71], v[232:235], v[84:87]
    s_sub_u32 s99, s99, s87
    v_mfma_f32_16x16x32_bf16 v[88:91], a[72:75], v[232:235], v[88:91]
    v_mfma_f32_16x16x32_bf16 v[92:95], a[76:79], v[232:235], v[92:95]
    s_waitcnt vmcnt(16)
    s_mov_b64 exec, s[60:61]
    buffer_store_dword v30, off, s[4:7], s74 offset:12
    s_mov_b64 exec, s[62:63]
    buffer_store_dword v30, off, s[4:7], s74 offset:12 sc1
    s_mov_b64 exec, -1
    s_waitcnt vmcnt(16)
    v_mfma_f32_16x16x32_bf16 v[64:67], a[64:67], v[160:163], v[64:67]
    buffer_load_dwordx4 a[188:191], v24, s[4:7], s99 offen offset:2048 sc1
    v_mfma_f32_16x16x32_bf16 v[68:71], a[68:71], v[160:163], v[68:71]
    v_mfma_f32_16x16x32_bf16 v[72:75], a[72:75], v[160:163], v[72:75]
    v_mfma_f32_16x16x32_bf16 v[76:79], a[76:79], v[160:163], v[76:79]
    s_waitcnt vmcnt(16)
    v_mfma_f32_16x16x32_bf16 v[32:35], a[96:99], v[164:167], v[32:35]
    buffer_load_dwordx4 a[192:195], v25, s[4:7], s96 offen offset:2048 sc1
    v_mfma_f32_16x16x32_bf16 v[36:39], a[100:103], v[164:167], v[36:39]
    v_mfma_f32_16x16x32_bf16 v[40:43], a[104:107], v[164:167], v[40:43]
    v_mfma_f32_16x16x32_bf16 v[44:47], a[108:111], v[164:167], v[44:47]
    s_waitcnt vmcnt(16)
    v_mfma_f32_16x16x32_bf16 v[48:51], a[96:99], v[168:171], v[48:51]
    buffer_load_dwordx4 a[196:199], v25, s[4:7], s97 offen offset:2048 sc1
    v_mfma_f32_16x16x32_bf16 v[52:55], a[100:103], v[168:171], v[52:55]
    v_mfma_f32_16x16x32_bf16 v[56:59], a[104:107], v[168:171], v[56:59]
    v_mfma_f32_16x16x32_bf16 v[60:63], a[108:111], v[168:171], v[60:63]
    s_waitcnt vmcnt(16)
    v_mfma_f32_16x16x32_bf16 v[80:83], a[96:99], v[172:175], v[80:83]
    buffer_load_dwordx4 a[200:203], v25, s[4:7], s98 offen offset:2048 sc1
    v_mfma_f32_16x16x32_bf16 v[84:87], a[100:103], v[172:175], v[84:87]
    v_mfma_f32_16x16x32_bf16 v[88:91], a[104:107], v[172:175], v[88:91]
    v_mfma_f32_16x16x32_bf16 v[92:95], a[108:111], v[172:175], v[92:95]
    s_waitcnt vmcnt(16)
    v_mfma_f32_16x16x32_bf16 v[64:67], a[96:99], v[96:99], v[64:67]
    buffer_load_dwordx4 a[204:207], v25, s[4:7], s99 offen offset:2048 sc1
    v_mfma_f32_16x16x32_bf16 v[68:71], a[100:103], v[96:99], v[68:71]
    v_mfma_f32_16x16x32_bf16 v[72:75], a[104:107], v[96:99], v[72:75]
    v_mfma_f32_16x16x32_bf16 v[76:79], a[108:111], v[96:99], v[76:79]
    s_waitcnt vmcnt(8)
    v_mfma_f32_16x16x32_bf16 v[32:35], a[128:131], a[176:179], v[32:35]
    buffer_load_dwordx4 a[208:211], v26, s[4:7], s96 offen offset:2048 sc1
    v_mfma_f32_16x16x32_bf16 v[36:39], a[132:135], a[176:179], v[36:39]
    v_mfma_f32_16x16x32_bf16 v[40:43], a[136:139], a[176:179], v[40:43]
    v_mfma_f32_16x16x32_bf16 v[44:47], a[140:143], a[176:179], v[44:47]
    s_waitcnt vmcnt(8)
    v_mfma_f32_16x16x32_bf16 v[48:51], a[128:131], a[180:183], v[48:51]
    buffer_load_dwordx4 a[212:215], v26, s[4:7], s97 offen offset:2048 sc1
    v_mfma_f32_16x16x32_bf16 v[52:55], a[132:135], a[180:183], v[52:55]
    v_mfma_f32_16x16x32_bf16 v[56:59], a[136:139], a[180:183], v[56:59]
    buffer_load_dword v240, v239, s[4:7], s76 offen offset:12 sc1
    v_mfma_f32_16x16x32_bf16 v[60:63], a[140:143], a[180:183], v[60:63]
    s_waitcnt vmcnt(9)
    v_mfma_f32_16x16x32_bf16 v[80:83], a[128:131], a[184:187], v[80:83]
    buffer_load_dwordx4 a[216:219], v26, s[4:7], s98 offen offset:2048 sc1
    v_mfma_f32_16x16x32_bf16 v[84:87], a[132:135], a[184:187], v[84:87]
    v_mfma_f32_16x16x32_bf16 v[88:91], a[136:139], a[184:187], v[88:91]
    v_mfma_f32_16x16x32_bf16 v[92:95], a[140:143], a[184:187], v[92:95]
    s_waitcnt vmcnt(8)
    v_mfma_f32_16x16x32_bf16 v[64:67], a[128:131], a[188:191], v[64:67]
    buffer_load_dwordx4 a[220:223], v26, s[4:7], s99 offen offset:2048 sc1
    v_mfma_f32_16x16x32_bf16 v[68:71], a[132:135], a[188:191], v[68:71]
    s_add_u32 s96, s96, s88
    v_mfma_f32_16x16x32_bf16 v[72:75], a[136:139], a[188:191], v[72:75]
    v_mfma_f32_16x16x32_bf16 v[76:79], a[140:143], a[188:191], v[76:79]
    s_waitcnt vmcnt(8)
    v_mfma_f32_16x16x32_bf16 v[32:35], a[144:147], a[192:195], v[32:35]
    v_mfma_f32_16x16x32_bf16 v[36:39], a[148:151], a[192:195], v[36:39]
    v_mfma_f32_16x16x32_bf16 v[40:43], a[152:155], a[192:195], v[40:43]
    v_mfma_f32_16x16x32_bf16 v[44:47], a[156:159], a[192:195], v[44:47]
    s_waitcnt vmcnt(7)
    v_mfma_f32_16x16x32_bf16 v[48:51], a[144:147], a[196:199], v[48:51]
    v_mfma_f32_16x16x32_bf16 v[52:55], a[148:151], a[196:199], v[52:55]
    v_mfma_f32_16x16x32_bf16 v[56:59], a[152:155], a[196:199], v[56:59]
    v_mfma_f32_16x16x32_bf16 v[60:63], a[156:159], a[196:199], v[60:63]
    s_waitcnt vmcnt(6)
    v_mfma_f32_16x16x32_bf16 v[80:83], a[144:147], a[200:203], v[80:83]
    v_mfma_f32_16x16x32_bf16 v[84:87], a[148:151], a[200:203], v[84:87]
    v_mfma_f32_16x16x32_bf16 v[88:91], a[152:155], a[200:203], v[88:91]
    v_mfma_f32_16x16x32_bf16 v[92:95], a[156:159], a[200:203], v[92:95]
    s_waitcnt vmcnt(5)
    v_mfma_f32_16x16x32_bf16 v[64:67], a[144:147], a[204:207], v[64:67]
    v_mfma_f32_16x16x32_bf16 v[68:71], a[148:151], a[204:207], v[68:71]
    v_mfma_f32_16x16x32_bf16 v[72:75], a[152:155], a[204:207], v[72:75]
    v_mfma_f32_16x16x32_bf16 v[76:79], a[156:159], a[204:207], v[76:79]
    s_waitcnt vmcnt(4)
    v_mfma_f32_16x16x32_bf16 v[32:35], a[160:163], a[208:211], v[32:35]
    s_waitcnt vmcnt(2)
    v_cmp_ne_u32 vcc, s28, v240
    s_cbranch_vccnz L_pB0_re
L_pB0_ok:
    buffer_load_dwordx4 a[224:227], v1, s[4:7], s96 offen offset:1024 sc1
    s_add_u32 s96, s96, s84
    buffer_load_dwordx4 a[228:231], v1, s[4:7], s96 offen offset:1024 sc1
    s_add_u32 s96, s96, s85
    buffer_load_dwordx4 a[232:235], v1, s[4:7], s96 offen offset:1024 sc1
    s_add_u32 s96, s96, s86
    buffer_load_dwordx4 a[236:239], v1, s[4:7], s96 offen offset:1024 sc1
    s_add_u32 s97, s97, s88
    buffer_load_dwordx4 a[240:243], v1, s[4:7], s97 offen offset:1024 sc1
    s_add_u32 s97, s97, s84
    buffer_load_dwordx4 a[244:247], v1, s[4:7], s97 offen offset:1024 sc1
    s_add_u32 s97, s97, s85
    buffer_load_dwordx4 a[248:251], v1, s[4:7], s97 offen offset:1024 sc1
    s_add_u32 s97, s97, s86
    buffer_load_dwordx4 a[252:255], v1, s[4:7], s97 offen offset:1024 sc1
    s_add_u32 s98, s98, s88
    buffer_load_dwordx4 v[128:131], v1, s[4:7], s98 offen offset:1024 sc1
    s_add_u32 s98, s98, s84
    buffer_load_dwordx4 v[132:135], v1, s[4:7], s98 offen offset:1024 sc1
    v_mfma_f32_16x16x32_bf16 v[36:39], a[164:167], a[208:211], v[36:39]
    s_add_u32 s98, s98, s85
    v_mfma_f32_16x16x32_bf16 v[40:43], a[168:171], a[208:211], v[40:43]
    v_mfma_f32_16x16x32_bf16 v[44:47], a[172:175], a[208:211], v[44:47]
    s_waitcnt vmcnt(13)
    v_mfma_f32_16x16x32_bf16 v[48:51], a[160:163], a[212:215], v[48:51]
    buffer_load_dwordx4 v[136:139], v1, s[4:7], s98 offen offset:1024 sc1
    v_mfma_f32_16x16x32_bf16 v[52:55], a[164:167], a[212:215], v[52:55]
    s_add_u32 s98, s98, s86
    v_mfma_f32_16x16x32_bf16 v[56:59], a[168:171], a[212:215], v[56:59]
    v_mfma_f32_16x16x32_bf16 v[60:63], a[172:175], a[212:215], v[60:63]
    s_waitcnt vmcnt(12)
    v_mfma_f32_16x16x32_bf16 v[80:83], a[160:163], a[216:219], v[80:83]
    buffer_load_dwordx4 v[140:143], v1, s[4:7], s98 offen offset:1024 sc1
    v_mfma_f32_16x16x32_bf16 v[84:87], a[164:167], a[216:219], v[84:87]
    s_add_u32 s99, s99, s88
    v_mfma_f32_16x16x32_bf16 v[88:91], a[168:171], a[216:219], v[88:91]
    v_mfma_f32_16x16x32_bf16 v[92:95], a[172:175], a[216:219], v[92:95]
    s_waitcnt vmcnt(12)
    v_mfma_f32_16x16x32_bf16 v[64:67], a[160:163], a[220:223], v[64:67]
    buffer_load_dwordx4 v[144:147], v1, s[4:7], s99 offen offset:1024 sc1
    v_mfma_f32_16x16x32_bf16 v[68:71], a[164:167], a[220:223], v[68:71]
    s_add_u32 s99, s99, s84
    v_mfma_f32_16x16x32_bf16 v[72:75], a[168:171], a[220:223], v[72:75]
    v_mfma_f32_16x16x32_bf16 v[76:79], a[172:175], a[220:223], v[76:79]
    s_waitcnt vmcnt(12)
    v_mfma_f32_16x16x32_bf16 v[32:35], a[16:19], a[224:227], v[32:35]
    buffer_load_dwordx4 v[148:151], v1, s[4:7], s99 offen offset:1024 sc1
    v_mfma_f32_16x16x32_bf16 v[36:39], a[20:23], a[224:227], v[36:39]
    s_add_u32 s99, s99, s85
    v_mfma_f32_16x16x32_bf16 v[40:43], a[24:27], a[224:227], v[40:43]
    v_mfma_f32_16x16x32_bf16 v[44:47], a[28:31], a[224:227], v[44:47]
    s_waitcnt vmcnt(12)
    v_mfma_f32_16x16x32_bf16 v[32:35], a[48:51], a[228:231], v[32:35]
    buffer_load_dwordx4 v[152:155], v1, s[4:7], s99 offen offset:1024 sc1
    v_mfma_f32_16x16x32_bf16 v[36:39], a[52:55], a[228:231], v[36:39]
    s_add_u32 s99, s99, s86
    v_mfma_f32_16x16x32_bf16 v[40:43], a[56:59], a[228:231], v[40:43]
    v_mfma_f32_16x16x32_bf16 v[44:47], a[60:63], a[228:231], v[44:47]
    s_waitcnt vmcnt(12)
    v_mfma_f32_16x16x32_bf16 v[32:35], a[80:83], a[232:235], v[32:35]
    buffer_load_dwordx4 v[156:159], v1, s[4:7], s99 offen offset:1024 sc1
    v_mfma_f32_16x16x32_bf16 v[36:39], a[84:87], a[232:235], v[36:39]
    v_mfma_f32_16x16x32_bf16 v[40:43], a[88:91], a[232:235], v[40:43]
    v_mfma_f32_16x16x32_bf16 v[44:47], a[92:95], a[232:235], v[44:47]
    s_waitcnt vmcnt(12)
    v_mfma_f32_16x16x32_bf16 v[32:35], a[112:115], a[236:239], v[32:35]
    v_mfma_f32_16x16x32_bf16 v[36:39], a[116:119], a[236:239], v[36:39]
    v_mfma_f32_16x16x32_bf16 v[40:43], a[120:123], a[236:239], v[40:43]
    v_mfma_f32_16x16x32_bf16 v[44:47], a[124:127], a[236:239], v[44:47]
    s_waitcnt vmcnt(11)
    v_mfma_f32_16x16x32_bf16 v[48:51], a[16:19], a[240:243], v[48:51]
    v_mfma_f32_16x16x32_bf16 v[52:55], a[20:23], a[240:243], v[52:55]
    v_mfma_f32_16x16x32_bf16 v[56:59], a[24:27], a[240:243], v[56:59]
    v_mfma_f32_16x16x32_bf16 v[60:63], a[28:31], a[240:243], v[60:63]
    ds_write_b128 v12, v[32:35] offset:0
    s_waitcnt vmcnt(10)
    v_mfma_f32_16x16x32_bf16 v[48:51], a[48:51], a[244:247], v[48:51]
    v_mfma_f32_16x16x32_bf16 v[52:55], a[52:55], a[244:247], v[52:55]
    ds_write_b128 v12, v[36:39] offset:1024
    v_mfma_f32_16x16x32_bf16 v[56:59], a[56:59], a[244:247], v[56:59]
    v_mfma_f32_16x16x32_bf16 v[60:63], a[60:63], a[244:247], v[60:63]
    s_waitcnt vmcnt(9)
    v_mfma_f32_16x16x32_bf16 v[48:51], a[80:83], a[248:251], v[48:51]
    v_mfma_f32_16x16x32_bf16 v[52:55], a[84:87], a[248:251], v[52:55]
    ds_write_b128 v12, v[40:43] offset:2048
    v_mfma_f32_16x16x32_bf16 v[56:59], a[88:91], a[248:251], v[56:59]
    v_mfma_f32_16x16x32_bf16 v[60:63], a[92:95], a[248:251], v[60:63]
    s_waitcnt vmcnt(8)
    v_mfma_f32_16x16x32_bf16 v[48:51], a[112:115], a[252:255], v[48:51]
    v_mfma_f32_16x16x32_bf16 v[52:55], a[116:119], a[252:255], v[52:55]
    ds_write_b128 v12, v[44:47] offset:3072
    v_mfma_f32_16x16x32_bf16 v[56:59], a[120:123], a[252:255], v[56:59]
    v_mfma_f32_16x16x32_bf16 v[60:63], a[124:127], a[252:255], v[60:63]
    s_waitcnt vmcnt(7)
    v_mfma_f32_16x16x32_bf16 v[80:83], a[16:19], v[128:131], v[80:83]
    v_mfma_f32_16x16x32_bf16 v[84:87], a[20:23], v[128:131], v[84:87]
    v_mfma_f32_16x16x32_bf16 v[88:91], a[24:27], v[128:131], v[88:91]
    v_mfma_f32_16x16x32_bf16 v[92:95], a[28:31], v[128:131], v[92:95]
    ds_write_b128 v13, v[48:51] offset:0
    s_waitcnt vmcnt(6)
    v_mfma_f32_16x16x32_bf16 v[80:83], a[48:51], v[132:135], v[80:83]
    v_mfma_f32_16x16x32_bf16 v[84:87], a[52:55], v[132:135], v[84:87]
    ds_write_b128 v13, v[52:55] offset:1024
    v_mfma_f32_16x16x32_bf16 v[88:91], a[56:59], v[132:135], v[88:91]
    v_mfma_f32_16x16x32_bf16 v[92:95], a[60:63], v[132:135], v[92:95]
    s_waitcnt vmcnt(5)
    v_mfma_f32_16x16x32_bf16 v[80:83], a[80:83], v[136:139], v[80:83]
    v_mfma_f32_16x16x32_bf16 v[84:87], a[84:87], v[136:139], v[84:87]
    ds_write_b128 v13, v[56:59] offset:2048
    v_mfma_f32_16x16x32_bf16 v[88:91], a[88:91], v[136:139], v[88:91]
    v_mfma_f32_16x16x32_bf16 v[92:95], a[92:95], v[136:139], v[92:95]
    s_waitcnt vmcnt(4)
    v_mfma_f32_16x16x32_bf16 v[80:83], a[112:115], v[140:143], v[80:83]
    v_mfma_f32_16x16x32_bf16 v[84:87], a[116:119], v[140:143], v[84:87]
    ds_write_b128 v13, v[60:63] offset:3072
    v_mfma_f32_16x16x32_bf16 v[88:91], a[120:123], v[140:143], v[88:91]
    v_mfma_f32_16x16x32_bf16 v[92:95], a[124:127], v[140:143], v[92:95]
    s_waitcnt vmcnt(3)
    v_mfma_f32_16x16x32_bf16 v[64:67], a[16:19], v[144:147], v[64:67]
    s_waitcnt lgkmcnt(0)
    s_barrier
    ds_read_b128 v[100:103], v15 offset:0
    v_mfma_f32_16x16x32_bf16 v[68:71], a[20:23], v[144:147], v[68:71]
    v_mfma_f32_16x16x32_bf16 v[72:75], a[24:27], v[144:147], v[72:75]
    ds_read_b128 v[116:119], v15 offset:4096
    ds_read_b128 v[104:107], v15 offset:1024
    v_mfma_f32_16x16x32_bf16 v[76:79], a[28:31], v[144:147], v[76:79]
    ds_read_b128 v[120:123], v15 offset:5120
    ds_write_b128 v14, v[80:83] offset:0
    s_waitcnt vmcnt(2)
    v_mfma_f32_16x16x32_bf16 v[64:67], a[48:51], v[148:151], v[64:67]
    ds_read_b128 v[108:111], v15 offset:2048
    v_mfma_f32_16x16x32_bf16 v[68:71], a[52:55], v[148:151], v[68:71]
    ds_write_b128 v14, v[84:87] offset:1024
    v_mfma_f32_16x16x32_bf16 v[72:75], a[56:59], v[148:151], v[72:75]
    ds_read_b128 v[124:127], v15 offset:6144
    ds_read_b128 v[112:115], v15 offset:3072
    v_mfma_f32_16x16x32_bf16 v[76:79], a[60:63], v[148:151], v[76:79]
    ds_read_b128 v[128:131], v15 offset:7168
    s_waitcnt vmcnt(1)
    v_mfma_f32_16x16x32_bf16 v[64:67], a[80:83], v[152:155], v[64:67]
    s_waitcnt lgkmcnt(8)
    v_add_f32 v100, v100, v116
    v_add_f32 v101, v101, v117
    v_mfma_f32_16x16x32_bf16 v[68:71], a[84:87], v[152:155], v[68:71]
    v_add_f32 v102, v102, v118
    v_add_f32 v103, v103, v119
    ds_write_b128 v14, v[88:91] offset:2048
    v_mfma_f32_16x16x32_bf16 v[72:75], a[88:91], v[152:155], v[72:75]
    s_waitcnt lgkmcnt(7)
    v_add_f32 v104, v104, v120
    v_add_f32 v105, v105, v121
    v_mfma_f32_16x16x32_bf16 v[76:79], a[92:95], v[152:155], v[76:79]
    v_add_f32 v106, v106, v122
    v_add_f32 v107, v107, v123
    s_waitcnt vmcnt(0)
    v_mfma_f32_16x16x32_bf16 v[64:67], a[112:115], v[156:159], v[64:67]
    s_waitcnt lgkmcnt(3)
    v_add_f32 v108, v108, v124
    v_add_f32 v109, v109, v125
    v_mfma_f32_16x16x32_bf16 v[68:71], a[116:119], v[156:159], v[68:71]
    v_add_f32 v110, v110, v126
    v_add_f32 v111, v111, v127
    ds_write_b128 v14, v[92:95] offset:3072
    v_mfma_f32_16x16x32_bf16 v[72:75], a[120:123], v[156:159], v[72:75]
    s_waitcnt lgkmcnt(2)
    v_add_f32 v112, v112, v128
    v_add_f32 v113, v113, v129
    v_mfma_f32_16x16x32_bf16 v[76:79], a[124:127], v[156:159], v[76:79]
    v_add_f32 v114, v114, v130
    v_add_f32 v115, v115, v131
    s_waitcnt lgkmcnt(0)
    s_barrier
    ds_read_b128 v[116:119], v15 offset:8192
    ds_read_b128 v[120:123], v15 offset:9216
    ds_read_b128 v[124:127], v15 offset:10240
    ds_read_b128 v[128:131], v15 offset:11264
    s_lshl_b32 s83, s35, 10
    s_add_u32 s83, s83, s66
    v_pk_add_f32 v[64:65], v[64:65], v[100:101]
    v_pk_add_f32 v[66:67], v[66:67], v[102:103]
    v_pk_add_f32 v[68:69], v[68:69], v[104:105]
    v_pk_add_f32 v[70:71], v[70:71], v[106:107]
    v_pk_add_f32 v[72:73], v[72:73], v[108:109]
    v_pk_add_f32 v[74:75], v[74:75], v[110:111]
    v_pk_add_f32 v[76:77], v[76:77], v[112:113]
    v_pk_add_f32 v[78:79], v[78:79], v[114:115]
    s_waitcnt lgkmcnt(3)
    v_pk_add_f32 v[64:65], v[64:65], v[116:117]
    v_pk_add_f32 v[66:67], v[66:67], v[118:119]
    s_waitcnt lgkmcnt(2)
    v_pk_add_f32 v[68:69], v[68:69], v[120:121]
    v_pk_add_f32 v[70:71], v[70:71], v[122:123]
    s_waitcnt lgkmcnt(1)
    v_pk_add_f32 v[72:73], v[72:73], v[124:125]
    v_pk_add_f32 v[74:75], v[74:75], v[126:127]
    s_waitcnt lgkmcnt(0)
    v_pk_add_f32 v[76:77], v[76:77], v[128:129]
    v_pk_add_f32 v[78:79], v[78:79], v[130:131]
    v_pk_add_f32 v[60:61], v[64:65], v[66:67]
    v_pk_mul_f32 v[62:63], v[64:65], v[64:65]
    v_pk_fma_f32 v[62:63], v[66:67], v[66:67], v[62:63]
    v_pk_add_f32 v[60:61], v[60:61], v[68:69]
    v_pk_fma_f32 v[62:63], v[68:69], v[68:69], v[62:63]
    v_pk_add_f32 v[60:61], v[60:61], v[70:71]
    v_pk_fma_f32 v[62:63], v[70:71], v[70:71], v[62:63]
    v_pk_add_f32 v[60:61], v[60:61], v[72:73]
    v_pk_fma_f32 v[62:63], v[72:73], v[72:73], v[62:63]
    v_pk_add_f32 v[60:61], v[60:61], v[74:75]
    v_pk_fma_f32 v[62:63], v[74:75], v[74:75], v[62:63]
    v_pk_add_f32 v[60:61], v[60:61], v[76:77]
    v_pk_fma_f32 v[62:63], v[76:77], v[76:77], v[62:63]
    v_pk_add_f32 v[60:61], v[60:61], v[78:79]
    v_pk_fma_f32 v[62:63], v[78:79], v[78:79], v[62:63]
    v_add_f32 v48, v60, v61
    v_add_f32 v49, v62, v63
    s_nop 1
    v_permlane32_swap_b32 v48, v49
    v_add_f32 v48, v48, v49
    v_mov_b32 v49, v48
    s_nop 1
    v_permlane16_swap_b32 v48, v49
    v_add_f32 v48, v48, v49
    v_mov_b32 v49, s28
    s_mov_b64 exec, s[56:57]
    buffer_store_dwordx2 v[48:49], v245, s[4:7], s83 offen
    s_mov_b64 exec, s[58:59]
    buffer_store_dwordx2 v[48:49], v245, s[4:7], s83 offen sc1
    s_mov_b64 exec, -1
    s_add_u32 s92, s66, 4096
    s_add_u32 s67, s67, 2097152
    s_add_u32 s93, s72, 8388608
    v_cvt_pk_bf16_f32 v80, v64, v65
    v_cvt_pk_bf16_f32 v81, v66, v67
    v_cvt_pk_bf16_f32 v82, v68, v69
    v_cvt_pk_bf16_f32 v83, v70, v71
    v_cvt_pk_bf16_f32 v84, v72, v73
    v_cvt_pk_bf16_f32 v85, v74, v75
    v_cvt_pk_bf16_f32 v86, v76, v77
    v_cvt_pk_bf16_f32 v87, v78, v79
    s_lshl_b32 s82, s37, 4
    v_add_u32 v60, s82, v2
    v_lshrrev_b32 v61, 1, v60
    v_cmp_eq_u32 vcc, 1, v60
    v_and_b32 v62, 1, v60
    v_cvt_f32_u32 v63, v3
    v_cndmask_b32 v61, v61, 32, vcc
    v_cndmask_b32 v62, v62, 0, vcc
    v_and_b32 v60, 1, v61
    v_cvt_f32_u32 v61, v61
    v_cvt_f32_u32 v62, v62
    v_mul_f32 v61, 0x3c800000, v61
    v_mul_f32 v62, 0x3e800000, v62
    v_mul_f32 v63, 0x41000000, v63
    v_fma_f32 v62, v61, v63, v62
    v_mul_u32_u24 v60, 0x8000, v60
    v_lshl_or_b32 v60, v60, 16, v60
    v_fmamk_f32 v136, v61, 0x00000000, v62
    v_cos_f32 v136, v136
    v_fmamk_f32 v137, v61, 0x40000000, v62
    v_cos_f32 v137, v137
    s_nop 0
    v_cvt_pk_bf16_f32 v88, v136, v137
    v_xor_b32 v90, v60, v88
    v_fmamk_f32 v136, v61, 0x40800000, v62
    v_cos_f32 v136, v136
    v_fmamk_f32 v137, v61, 0x40c00000, v62
    v_cos_f32 v137, v137
    s_nop 0
    v_cvt_pk_bf16_f32 v89, v136, v137
    v_xor_b32 v91, v60, v89
    v_fmamk_f32 v136, v61, 0x3f800000, v62
    v_cos_f32 v136, v136
    v_fmamk_f32 v137, v61, 0x40400000, v62
    v_cos_f32 v137, v137
    s_nop 0
    v_cvt_pk_bf16_f32 v92, v136, v137
    v_xor_b32 v94, v60, v92
    v_fmamk_f32 v136, v61, 0x40a00000, v62
    v_cos_f32 v136, v136
    v_fmamk_f32 v137, v61, 0x40e00000, v62
    v_cos_f32 v137, v137
    s_nop 0
    v_cvt_pk_bf16_f32 v93, v136, v137
    v_xor_b32 v95, v60, v93
    s_mov_b32 s82, 0
L_pS1:
    buffer_load_dwordx4 v[52:55], v5, s[4:7], s66 offen sc1
    buffer_load_dwordx4 v[56:59], v5, s[4:7], s92 offen sc1
    s_waitcnt vmcnt(0)
    v_cmp_eq_u32 vcc, s28, v53
    v_cmp_eq_u32 s[84:85], s28, v55
    v_cmp_eq_u32 s[86:87], s28, v57
    v_cmp_eq_u32 s[88:89], s28, v59
    s_and_b64 vcc, vcc, s[84:85]
    s_and_b64 vcc, vcc, s[86:87]
    s_and_b64 vcc, vcc, s[88:89]
    s_cmp_eq_u64 vcc, exec
    s_cbranch_scc1 L_pS1_ok
    s_add_u32 s82, s82, 1
    s_cmp_lt_u32 s82, 400000
    s_cbranch_scc1 L_pS1
L_pS1_ok:
    buffer_store_dwordx4 v[80:83], v1, s[4:7], s93 offen sc1
    v_add_f32 v48, v52, v56
    v_add_f32 v49, v54, v58
    s_nop 1
    v_permlane32_swap_b32 v48, v49
    v_add_f32 v48, v48, v49
    v_mov_b32 v49, v48
    s_nop 1
    v_permlane16_swap_b32 v48, v49
    v_add_f32 v48, v48, v49
    v_mov_b32 v49, v48
    buffer_store_dwordx4 v[84:87], v1, s[4:7], s93 offen offset:1024 sc1
    s_nop 0
    v_permlane32_swap_b32 v48, v49
    v_mul_f32 v48, s64, v48
    v_mul_f32 v61, v48, v48
    v_fma_f32 v49, v49, s64, -v61
    v_max_f32 v49, 0, v49
    v_add_f32 v49, 0x3727c5ac, v49
    v_rsq_f32 v60, v49
    s_nop 0
    v_mul_f32 v61, v48, v60
    v_pk_fma_f32 v[64:65], v[64:65], v[60:61], v[60:61] op_sel:[0,0,1] op_sel_hi:[1,0,1] neg_lo:[0,0,1] neg_hi:[0,0,1]
    v_cvt_pk_bf16_f32 v128, v64, v65
    v_pk_fma_f32 v[66:67], v[66:67], v[60:61], v[60:61] op_sel:[0,0,1] op_sel_hi:[1,0,1] neg_lo:[0,0,1] neg_hi:[0,0,1]
    v_cvt_pk_bf16_f32 v129, v66, v67
    ds_write_b64 v6, v[128:129] offset:0
    v_pk_fma_f32 v[68:69], v[68:69], v[60:61], v[60:61] op_sel:[0,0,1] op_sel_hi:[1,0,1] neg_lo:[0,0,1] neg_hi:[0,0,1]
    v_cvt_pk_bf16_f32 v130, v68, v69
    v_pk_fma_f32 v[70:71], v[70:71], v[60:61], v[60:61] op_sel:[0,0,1] op_sel_hi:[1,0,1] neg_lo:[0,0,1] neg_hi:[0,0,1]
    v_cvt_pk_bf16_f32 v131, v70, v71
    ds_write_b64 v6, v[130:131] offset:32
    v_pk_fma_f32 v[72:73], v[72:73], v[60:61], v[60:61] op_sel:[0,0,1] op_sel_hi:[1,0,1] neg_lo:[0,0,1] neg_hi:[0,0,1]
    v_cvt_pk_bf16_f32 v132, v72, v73
    v_pk_fma_f32 v[74:75], v[74:75], v[60:61], v[60:61] op_sel:[0,0,1] op_sel_hi:[1,0,1] neg_lo:[0,0,1] neg_hi:[0,0,1]
    v_cvt_pk_bf16_f32 v133, v74, v75
    ds_write_b64 v6, v[132:133] offset:64
    v_pk_fma_f32 v[76:77], v[76:77], v[60:61], v[60:61] op_sel:[0,0,1] op_sel_hi:[1,0,1] neg_lo:[0,0,1] neg_hi:[0,0,1]
    v_cvt_pk_bf16_f32 v134, v76, v77
    v_pk_fma_f32 v[78:79], v[78:79], v[60:61], v[60:61] op_sel:[0,0,1] op_sel_hi:[1,0,1] neg_lo:[0,0,1] neg_hi:[0,0,1]
    v_cvt_pk_bf16_f32 v135, v78, v79
    ds_write_b64 v6, v[134:135] offset:96
    s_waitcnt lgkmcnt(0)
    s_barrier
    ds_read_b64_tr_b16 v[96:97], v7 offset:0
    ds_read_b64_tr_b16 v[98:99], v7 offset:2560
    ds_read_b64_tr_b16 v[100:101], v7 offset:5120
    ds_read_b64_tr_b16 v[102:103], v7 offset:7680
    ds_read_b64_tr_b16 v[104:105], v7 offset:32
    ds_read_b64_tr_b16 v[106:107], v7 offset:2592
    ds_read_b64_tr_b16 v[108:109], v7 offset:5152
    ds_read_b64_tr_b16 v[110:111], v7 offset:7712
    ds_read_b64_tr_b16 v[112:113], v7 offset:64
    ds_read_b64_tr_b16 v[114:115], v7 offset:2624
    ds_read_b64_tr_b16 v[116:117], v7 offset:5184
    ds_read_b64_tr_b16 v[118:119], v7 offset:7744
    ds_read_b64_tr_b16 v[120:121], v7 offset:96
    ds_read_b64_tr_b16 v[122:123], v7 offset:2656
    ds_read_b64_tr_b16 v[124:125], v7 offset:5216
    ds_read_b64_tr_b16 v[126:127], v7 offset:7776
    s_waitcnt lgkmcnt(12)
    v_mfma_f32_16x16x32_bf16 v[32:35], v[96:99], v[88:91], 0
    v_mfma_f32_16x16x32_bf16 v[32:35], v[100:103], v[92:95], v[32:35]
    s_waitcnt lgkmcnt(8)
    v_mfma_f32_16x16x32_bf16 v[36:39], v[104:107], v[88:91], 0
    v_mfma_f32_16x16x32_bf16 v[36:39], v[108:111], v[92:95], v[36:39]
    s_waitcnt lgkmcnt(4)
    v_mfma_f32_16x16x32_bf16 v[40:43], v[112:115], v[88:91], 0
    v_mfma_f32_16x16x32_bf16 v[40:43], v[116:119], v[92:95], v[40:43]
    s_waitcnt lgkmcnt(0)
    v_mfma_f32_16x16x32_bf16 v[44:47], v[120:123], v[88:91], 0
    v_mfma_f32_16x16x32_bf16 v[44:47], v[124:127], v[92:95], v[44:47]
    v_cvt_pk_bf16_f32 v128, v32, v33
    v_cvt_pk_bf16_f32 v129, v34, v35
    v_cvt_pk_bf16_f32 v130, v36, v37
    v_cvt_pk_bf16_f32 v131, v38, v39
    buffer_store_dwordx4 v[128:131], v8, s[4:7], s67 offen sc1
    v_cvt_pk_bf16_f32 v132, v40, v41
    v_cvt_pk_bf16_f32 v133, v42, v43
    s_nop 0
    v_cvt_pk_bf16_f32 v134, v44, v45
    v_cvt_pk_bf16_f32 v135, v46, v47
    buffer_store_dwordx4 v[132:135], v8, s[4:7], s67 offen offset:128 sc1
    s_add_u32 s68, s68, 131072
    s_add_u32 s69, s69, 131072
    s_add_u32 s70, s70, 2097152
    s_add_u32 s72, s72, 2097152
    s_add_u32 s77, s77, 131072
    s_add_u32 s0, s0, 131072
    s_add_u32 s73, s73, 2097152
    s_add_u32 s74, s74, 64
    s_add_u32 s75, s75, 2097152
    s_add_u32 s76, s76, 64
    s_add_u32 s78, s78, 5767168
    s_add_u32 s79, s79, 5767168
    s_add_u32 s8, s52, 13631488
    s_addc_u32 s9, s53, 0
    s_lshl_b32 s82, s37, 5
    s_add_u32 s71, s81, s82
    s_add_u32 s80, s71, 16
    v_lshlrev_b32 v23, 4, v23
    s_waitcnt vmcnt(0)
    s_mov_b64 exec, 1
    buffer_store_dword v30, off, s[4:7], s68 sc1
    s_mov_b64 exec, -1
    s_getpc_b64 s[84:85]
L_pf_1:
    s_mul_i32 s82, s37, 4608
    v_min_u32 v36, 35, v0
    v_lshlrev_b32 v36, 7, v36
    v_add_u32 v36, s82, v36
    v_min_u32 v36, L_end-L_pf_1, v36
    global_load_dword v169, v36, s[84:85]
    s_cmp_eq_u32 s43, 32
    s_cselect_b32 s84, 0, 1.0
    s_cselect_b32 s85, 1.0, 0
    s_cmp_gt_u32 s43, 32
    s_cselect_b32 s86, -1.0, 1.0
    s_and_b32 s82, s43, 31
    s_cmp_eq_u32 s82, 0
    s_cselect_b32 s86, 0, s86
    v_lshrrev_b32 v32, 1, v2
    v_lshlrev_b32 v32, 6, v32
    v_add_u32 v32, s55, v32
    v_cvt_f32_u32 v32, v32
    v_and_b32 v33, 1, v2
    v_cvt_f32_u32 v39, v33
    v_cvt_f32_u32 v34, v3
    v_cvt_f32_u32 v40, v2
    v_mul_f32 v32, 0x3a000000, v32
    v_mul_f32 v39, 0x3e800000, v39
    v_add_f32 v35, v34, v34
    v_fma_f32 v39, v32, v35, v39
    v_mul_u32_u24 v33, 0x8000, v33
    v_lshl_or_b32 v33, v33, 16, v33
    v_mul_f32 v34, 4.0, v34
    v_fmamk_f32 v35, v32, 0x00000000, v39
    v_cos_f32 v36, v35
    v_sin_f32 v37, v35
    v_mul_f32 v38, s85, v36
    v_mul_f32 v36, s84, v36
    v_fma_f32 v37, v37, s86, v38
    v_cvt_pk_bf16_f32 v192, v36, v37
    v_fmamk_f32 v35, v32, 0x3f800000, v39
    v_cos_f32 v36, v35
    v_sin_f32 v37, v35
    v_mul_f32 v38, s85, v36
    v_mul_f32 v36, s84, v36
    v_fma_f32 v37, v37, s86, v38
    v_cvt_pk_bf16_f32 v193, v36, v37
    v_fmamk_f32 v35, v32, 0x41000000, v39
    v_cos_f32 v36, v35
    v_sin_f32 v37, v35
    v_mul_f32 v38, s85, v36
    v_mul_f32 v36, s84, v36
    v_fma_f32 v37, v37, s86, v38
    v_cvt_pk_bf16_f32 v194, v36, v37
    v_fmamk_f32 v35, v32, 0x41100000, v39
    v_cos_f32 v36, v35
    v_sin_f32 v37, v35
    v_mul_f32 v38, s85, v36
    v_mul_f32 v36, s84, v36
    v_fma_f32 v37, v37, s86, v38
    v_cvt_pk_bf16_f32 v195, v36, v37
    v_fmamk_f32 v35, v32, 0x41800000, v39
    v_cos_f32 v36, v35
    v_sin_f32 v37, v35
    v_mul_f32 v38, s85, v36
    v_mul_f32 v36, s84, v36
    v_fma_f32 v37, v37, s86, v38
    v_cvt_pk_bf16_f32 v196, v36, v37
    v_fmamk_f32 v35, v32, 0x41880000, v39
    v_cos_f32 v36, v35
    v_sin_f32 v37, v35
    v_mul_f32 v38, s85, v36
    v_mul_f32 v36, s84, v36
    v_fma_f32 v37, v37, s86, v38
    v_cvt_pk_bf16_f32 v197, v36, v37
    v_fmamk_f32 v35, v32, 0x41c00000, v39
    v_cos_f32 v36, v35
    v_sin_f32 v37, v35
    v_mul_f32 v38, s85, v36
    v_mul_f32 v36, s84, v36
    v_fma_f32 v37, v37, s86, v38
    v_cvt_pk_bf16_f32 v198, v36, v37
    v_fmamk_f32 v35, v32, 0x41c80000, v39
    v_cos_f32 v36, v35
    v_sin_f32 v37, v35
    v_mul_f32 v38, s85, v36
    v_mul_f32 v36, s84, v36
    v_fma_f32 v37, v37, s86, v38
    v_cvt_pk_bf16_f32 v199, v36, v37
    v_mul_f32 v32, 0x3d800000, v40
    v_mul_f32 v39, v32, v34
    v_fmamk_f32 v35, v32, 0x00000000, v39
    v_cos_f32 v44, v35
    v_sin_f32 v48, v35
    v_fmamk_f32 v35, v32, 0x3f800000, v39
    v_cos_f32 v45, v35
    v_sin_f32 v49, v35
    v_fmamk_f32 v35, v32, 0x40000000, v39
    v_cos_f32 v46, v35
    v_sin_f32 v50, v35
    v_fmamk_f32 v35, v32, 0x40400000, v39
    v_cos_f32 v47, v35
    v_sin_f32 v51, v35
    v_cvt_pk_bf16_f32 v202, v44, v45
    v_cvt_pk_bf16_f32 v203, v46, v47
    v_cvt_pk_bf16_f32 v204, v48, v49
    v_cvt_pk_bf16_f32 v205, v50, v51
    v_xor_b32 v200, 0x80008000, v204
    v_xor_b32 v201, 0x80008000, v205
    v_mul_f32 v32, 0x3b000000, v40
    v_mul_f32 v39, v32, v34
    v_fmamk_f32 v35, v32, 0x00000000, v39
    v_cos_f32 v206, v35
    v_sin_f32 v214, v35
    v_fmamk_f32 v35, v32, 0x3f800000, v39
    v_cos_f32 v207, v35
    v_sin_f32 v215, v35
    v_fmamk_f32 v35, v32, 0x40000000, v39
    v_cos_f32 v208, v35
    v_sin_f32 v216, v35
    v_fmamk_f32 v35, v32, 0x40400000, v39
    v_cos_f32 v209, v35
    v_sin_f32 v217, v35
    v_mul_f32 v32, 0x3b000000, v40
    v_mul_f32 v39, v32, v34
    v_fmamk_f32 v35, v32, 0x41800000, v39
    v_cos_f32 v210, v35
    v_sin_f32 v218, v35
    v_fmamk_f32 v35, v32, 0x41880000, v39
    v_cos_f32 v211, v35
    v_sin_f32 v219, v35
    v_fmamk_f32 v35, v32, 0x41900000, v39
    v_cos_f32 v212, v35
    v_sin_f32 v220, v35
    v_fmamk_f32 v35, v32, 0x41980000, v39
    v_cos_f32 v213, v35
    v_sin_f32 v221, v35
    v_mul_f32 v32, 0x3d000000, v40
    v_mul_f32 v39, v32, v34
    v_fmamk_f32 v35, v32, 0x00000000, v39
    v_cos_f32 v44, v35
    v_sin_f32 v48, v35
    v_fmamk_f32 v35, v32, 0x3f800000, v39
    v_cos_f32 v45, v35
    v_sin_f32 v49, v35
    v_fmamk_f32 v35, v32, 0x40000000, v39
    v_cos_f32 v46, v35
    v_sin_f32 v50, v35
    v_fmamk_f32 v35, v32, 0x40400000, v39
    v_cos_f32 v47, v35
    v_sin_f32 v51, v35
    v_cvt_pk_bf16_f32 v222, v44, v45
    v_cvt_pk_bf16_f32 v223, v46, v47
    v_xor_b32 v224, v33, v222
    v_xor_b32 v225, v33, v223
    v_cvt_pk_bf16_f32 v226, v48, v49
    v_cvt_pk_bf16_f32 v227, v50, v51
    v_xor_b32 v228, v33, v226
    v_xor_b32 v229, v33, v227
    v_xor_b32 v230, 0x80000000, v222
    v_xor_b32 v231, 0x80000000, v223
    v_xor_b32 v232, 0x80000000, v224
    v_xor_b32 v233, 0x80000000, v225
    v_xor_b32 v234, 0x80000000, v226
    v_xor_b32 v235, 0x80000000, v227
    v_xor_b32 v236, 0x80000000, v228
    v_xor_b32 v237, 0x80000000, v229
    s_mov_b32 s90, s70
    s_lshl_b32 s91, s37, 14
    s_add_u32 s91, s91, 81664
    s_mov_b32 m0, s91
    s_lshl_b32 s92, s32, 11
    s_add_u32 s92, s92, 98320
    v_lshlrev_b32 v41, 7, v2
    s_mov_b32 s82, 0
L_pG1:
    buffer_load_dword v36, v9, s[4:7], s69 offen sc1
    s_waitcnt vmcnt(0)
    v_cmp_eq_u32 vcc, s28, v36
    s_nop 0
    s_cmp_eq_u64 vcc, exec
    s_cbranch_scc1 L_pG1_ok
    s_add_u32 s82, s82, 1
    s_cmp_lt_u32 s82, 400000
    s_cbranch_scc1 L_pG1
L_pG1_ok:
    buffer_load_dwordx4 v16, s[4:7], s90 offen offset:0 sc1 lds
    s_add_u32 s90, s90, 15360
    buffer_load_dwordx4 v16, s[4:7], s90 offen offset:1024 sc1 lds
    s_add_u32 s90, s90, 15360
    buffer_load_dwordx4 v16, s[4:7], s90 offen offset:2048 sc1 lds
    s_add_u32 s90, s90, 15360
    buffer_load_dwordx4 v16, s[4:7], s90 offen offset:3072 sc1 lds
    s_sub_u32 s90, s90, 45952
    s_add_u32 m0, m0, 4096
    s_nop 0
    buffer_load_dwordx4 v16, s[4:7], s90 offen offset:0 sc1 lds
    s_add_u32 s90, s90, 15360
    buffer_load_dwordx4 v16, s[4:7], s90 offen offset:1024 sc1 lds
    s_add_u32 s90, s90, 15360
    buffer_load_dwordx4 v16, s[4:7], s90 offen offset:2048 sc1 lds
    s_add_u32 s90, s90, 15360
    buffer_load_dwordx4 v16, s[4:7], s90 offen offset:3072 sc1 lds
    s_sub_u32 s90, s90, 45952
    s_add_u32 m0, m0, 4096
    s_nop 0
    buffer_load_dwordx4 v16, s[4:7], s90 offen offset:0 sc1 lds
    s_add_u32 s90, s90, 15360
    buffer_load_dwordx4 v16, s[4:7], s90 offen offset:1024 sc1 lds
    s_add_u32 s90, s90, 15360
    buffer_load_dwordx4 v16, s[4:7], s90 offen offset:2048 sc1 lds
    s_add_u32 s90, s90, 15360
    buffer_load_dwordx4 v16, s[4:7], s90 offen offset:3072 sc1 lds
    s_sub_u32 s90, s90, 45952
    s_add_u32 m0, m0, 4096
    s_nop 0
    buffer_load_dwordx4 v16, s[4:7], s90 offen offset:0 sc1 lds
    s_add_u32 s90, s90, 15360
    buffer_load_dwordx4 v16, s[4:7], s90 offen offset:1024 sc1 lds
    s_add_u32 s90, s90, 15360
    buffer_load_dwordx4 v16, s[4:7], s90 offen offset:2048 sc1 lds
    s_add_u32 s90, s90, 15360
    buffer_load_dwordx4 v16, s[4:7], s90 offen offset:3072 sc1 lds
    s_barrier
    buffer_load_dwordx4 v[160:163], v23, s[8:11], s71 offen sc1
    buffer_load_dwordx4 v[164:167], v23, s[8:11], s80 offen sc1
    s_waitcnt vmcnt(14)
    ds_read_b64_tr_b16 v[96:97], v18 offset:0
    ds_read_b64_tr_b16 v[98:99], v18 offset:1024
    ds_read_b64_tr_b16 v[100:101], v18 offset:2048
    ds_read_b64_tr_b16 v[102:103], v18 offset:3072
    ds_read_b64_tr_b16 v[104:105], v17 offset:0
    ds_read_b64_tr_b16 v[106:107], v17 offset:1024
    ds_read_b64_tr_b16 v[108:109], v17 offset:2048
    ds_read_b64_tr_b16 v[110:111], v17 offset:3072
    s_waitcnt lgkmcnt(4)
    v_mfma_f32_16x16x32_bf16 v[32:35], v[96:99], v[192:195], 0
    v_mfma_f32_16x16x32_bf16 v[32:35], v[100:103], v[196:199], v[32:35]
    s_waitcnt lgkmcnt(0)
    v_mfma_f32_16x16x32_bf16 v[36:39], v[104:107], v[192:195], 0
    v_mfma_f32_16x16x32_bf16 v[36:39], v[108:111], v[196:199], v[36:39]
    s_waitcnt vmcnt(10)
    ds_read_b64_tr_b16 v[112:113], v18 offset:4096
    ds_read_b64_tr_b16 v[114:115], v18 offset:5120
    ds_read_b64_tr_b16 v[116:117], v18 offset:6144
    ds_read_b64_tr_b16 v[118:119], v18 offset:7168
    ds_read_b64_tr_b16 v[120:121], v17 offset:4096
    ds_read_b64_tr_b16 v[122:123], v17 offset:5120
    ds_read_b64_tr_b16 v[124:125], v17 offset:6144
    ds_read_b64_tr_b16 v[126:127], v17 offset:7168
    v_cvt_pk_bf16_f32 v64, v32, v33
    v_cvt_pk_bf16_f32 v65, v34, v35
    ds_write_b64 v19, v[64:65] offset:0
    v_cvt_pk_bf16_f32 v66, v36, v37
    v_cvt_pk_bf16_f32 v67, v38, v39
    ds_write_b64 v20, v[66:67] offset:0
    s_waitcnt lgkmcnt(6)
    v_mfma_f32_16x16x32_bf16 v[40:43], v[112:115], v[192:195], 0
    v_mfma_f32_16x16x32_bf16 v[40:43], v[116:119], v[196:199], v[40:43]
    s_waitcnt lgkmcnt(2)
    v_mfma_f32_16x16x32_bf16 v[44:47], v[120:123], v[192:195], 0
    v_mfma_f32_16x16x32_bf16 v[44:47], v[124:127], v[196:199], v[44:47]
    s_waitcnt vmcnt(6)
    ds_read_b64_tr_b16 v[128:129], v18 offset:8192
    ds_read_b64_tr_b16 v[130:131], v18 offset:9216
    ds_read_b64_tr_b16 v[132:133], v18 offset:10240
    ds_read_b64_tr_b16 v[134:135], v18 offset:11264
    ds_read_b64_tr_b16 v[136:137], v17 offset:8192
    ds_read_b64_tr_b16 v[138:139], v17 offset:9216
    ds_read_b64_tr_b16 v[140:141], v17 offset:10240
    ds_read_b64_tr_b16 v[142:143], v17 offset:11264
    v_cvt_pk_bf16_f32 v68, v40, v41
    v_cvt_pk_bf16_f32 v69, v42, v43
    ds_write_b64 v19, v[68:69] offset:64
    v_cvt_pk_bf16_f32 v70, v44, v45
    v_cvt_pk_bf16_f32 v71, v46, v47
    ds_write_b64 v20, v[70:71] offset:64
    s_waitcnt lgkmcnt(6)
    v_mfma_f32_16x16x32_bf16 v[48:51], v[128:131], v[192:195], 0
    v_mfma_f32_16x16x32_bf16 v[48:51], v[132:135], v[196:199], v[48:51]
    s_waitcnt lgkmcnt(2)
    v_mfma_f32_16x16x32_bf16 v[52:55], v[136:139], v[192:195], 0
    v_mfma_f32_16x16x32_bf16 v[52:55], v[140:143], v[196:199], v[52:55]
    s_waitcnt vmcnt(2)
    ds_read_b64_tr_b16 v[144:145], v18 offset:12288
    ds_read_b64_tr_b16 v[146:147], v18 offset:13312
    ds_read_b64_tr_b16 v[148:149], v18 offset:14336
    ds_read_b64_tr_b16 v[150:151], v18 offset:15360
    ds_read_b64_tr_b16 v[152:153], v17 offset:12288
    ds_read_b64_tr_b16 v[154:155], v17 offset:13312
    ds_read_b64_tr_b16 v[156:157], v17 offset:14336
    ds_read_b64_tr_b16 v[158:159], v17 offset:15360
    v_cvt_pk_bf16_f32 v72, v48, v49
    v_cvt_pk_bf16_f32 v73, v50, v51
    ds_write_b64 v19, v[72:73] offset:128
    v_cvt_pk_bf16_f32 v74, v52, v53
    v_cvt_pk_bf16_f32 v75, v54, v55
    ds_write_b64 v20, v[74:75] offset:128
    s_waitcnt lgkmcnt(6)
    v_mfma_f32_16x16x32_bf16 v[56:59], v[144:147], v[192:195], 0
    v_mfma_f32_16x16x32_bf16 v[56:59], v[148:151], v[196:199], v[56:59]
    s_waitcnt lgkmcnt(2)
    v_mfma_f32_16x16x32_bf16 v[60:63], v[152:155], v[192:195], 0
    v_mfma_f32_16x16x32_bf16 v[60:63], v[156:159], v[196:199], v[60:63]
    s_nop 4
    v_cvt_pk_bf16_f32 v76, v56, v57
    v_cvt_pk_bf16_f32 v77, v58, v59
    ds_write_b64 v19, v[76:77] offset:192
    v_cvt_pk_bf16_f32 v78, v60, v61
    v_cvt_pk_bf16_f32 v79, v62, v63
    ds_write_b64 v20, v[78:79] offset:192
    s_waitcnt lgkmcnt(0)
    s_barrier
    ds_read_b64_tr_b16 v[96:97], v21 offset:0
    ds_read_b64_tr_b16 v[98:99], v21 offset:1032
    ds_read_b64_tr_b16 v[100:101], v22 offset:0
    ds_read_b64_tr_b16 v[102:103], v22 offset:1032
    ds_read_b64_tr_b16 v[104:105], v21 offset:2064
    ds_read_b64_tr_b16 v[106:107], v21 offset:3096
    ds_read_b64_tr_b16 v[108:109], v22 offset:2064
    ds_read_b64_tr_b16 v[110:111], v22 offset:3096
    s_add_u32 s46, s78, 45056
    s_add_u32 s46, s78, 45056
    s_waitcnt lgkmcnt(4)
    v_mfma_f32_16x16x32_bf16 v[32:35], v[96:99], v[202:205], 0
    s_add_u32 m0, s47, 77824
    v_mfma_f32_16x16x32_bf16 v[40:43], v[96:99], v[200:203], 0
    buffer_load_dwordx4 v242, s[4:7], m0 offen sc1 lds
    v_mfma_f32_16x16x32_bf16 v[36:39], v[100:103], v[202:205], 0
    v_mfma_f32_16x16x32_bf16 v[44:47], v[100:103], v[200:203], 0
    s_waitcnt lgkmcnt(0)
    v_mfma_f32_16x16x32_bf16 v[48:51], v[104:107], v[202:205], 0
    v_mfma_f32_16x16x32_bf16 v[56:59], v[104:107], v[200:203], 0
    v_mfma_f32_16x16x32_bf16 v[52:55], v[108:111], v[202:205], 0
    v_mfma_f32_16x16x32_bf16 v[60:63], v[108:111], v[200:203], 0
    v_pk_mul_f32 v[64:65], v[40:41], v[214:215]
    v_pk_mul_f32 v[66:67], v[32:33], v[214:215]
    v_pk_fma_f32 v[64:65], v[32:33], v[206:207], v[64:65]
    v_pk_fma_f32 v[66:67], v[40:41], v[206:207], v[66:67] neg_lo:[0,0,1] neg_hi:[0,0,1]
    v_cvt_pk_bf16_f32 v112, v64, v65
    v_cvt_pk_bf16_f32 v116, v66, v67
    v_pk_mul_f32 v[64:65], v[42:43], v[216:217]
    v_pk_mul_f32 v[66:67], v[34:35], v[216:217]
    s_add_u32 m0, s47, 81920
    v_pk_fma_f32 v[64:65], v[34:35], v[208:209], v[64:65]
    buffer_load_dwordx4 v242, s[4:7], m0 offen sc1 lds
    v_pk_fma_f32 v[66:67], v[42:43], v[208:209], v[66:67] neg_lo:[0,0,1] neg_hi:[0,0,1]
    v_cvt_pk_bf16_f32 v113, v64, v65
    v_cvt_pk_bf16_f32 v117, v66, v67
    v_pk_mul_f32 v[64:65], v[44:45], v[218:219]
    v_pk_mul_f32 v[66:67], v[36:37], v[218:219]
    v_pk_fma_f32 v[64:65], v[36:37], v[210:211], v[64:65]
    v_pk_fma_f32 v[66:67], v[44:45], v[210:211], v[66:67] neg_lo:[0,0,1] neg_hi:[0,0,1]
    v_cvt_pk_bf16_f32 v114, v64, v65
    v_cvt_pk_bf16_f32 v118, v66, v67
    v_pk_mul_f32 v[64:65], v[46:47], v[220:221]
    v_pk_mul_f32 v[66:67], v[38:39], v[220:221]
    v_pk_fma_f32 v[64:65], v[38:39], v[212:213], v[64:65]
    v_pk_fma_f32 v[66:67], v[46:47], v[212:213], v[66:67] neg_lo:[0,0,1] neg_hi:[0,0,1]
    v_cvt_pk_bf16_f32 v115, v64, v65
    v_cvt_pk_bf16_f32 v119, v66, v67
    s_add_u32 m0, s47, 86016
    v_mfma_f32_16x16x32_bf16 v[80:83], v[112:115], v[222:225], 0
    buffer_load_dwordx4 v242, s[4:7], m0 offen sc1 lds
    v_mfma_f32_16x16x32_bf16 v[84:87], v[112:115], v[230:233], 0
    v_mfma_f32_16x16x32_bf16 v[80:83], v[116:119], v[226:229], v[80:83]
    v_mfma_f32_16x16x32_bf16 v[84:87], v[116:119], v[234:237], v[84:87]
    v_pk_mul_f32 v[64:65], v[56:57], v[214:215]
    v_pk_mul_f32 v[66:67], v[48:49], v[214:215]
    v_pk_fma_f32 v[64:65], v[48:49], v[206:207], v[64:65]
    v_pk_fma_f32 v[66:67], v[56:57], v[206:207], v[66:67] neg_lo:[0,0,1] neg_hi:[0,0,1]
    v_cvt_pk_bf16_f32 v120, v64, v65
    v_cvt_pk_bf16_f32 v124, v66, v67
    v_pk_mul_f32 v[64:65], v[58:59], v[216:217]
    v_pk_mul_f32 v[66:67], v[50:51], v[216:217]
    v_pk_fma_f32 v[64:65], v[50:51], v[208:209], v[64:65]
    v_pk_fma_f32 v[66:67], v[58:59], v[208:209], v[66:67] neg_lo:[0,0,1] neg_hi:[0,0,1]
    v_cvt_pk_bf16_f32 v121, v64, v65
    v_cvt_pk_bf16_f32 v125, v66, v67
    s_add_u32 m0, s47, 90112
    v_pk_mul_f32 v[64:65], v[60:61], v[218:219]
    buffer_load_dwordx4 v242, s[4:7], m0 offen sc1 lds
    v_pk_mul_f32 v[66:67], v[52:53], v[218:219]
    v_pk_fma_f32 v[64:65], v[52:53], v[210:211], v[64:65]
    v_pk_fma_f32 v[66:67], v[60:61], v[210:211], v[66:67] neg_lo:[0,0,1] neg_hi:[0,0,1]
    v_cvt_pk_bf16_f32 v122, v64, v65
    v_cvt_pk_bf16_f32 v126, v66, v67
    v_pk_mul_f32 v[64:65], v[62:63], v[220:221]
    v_pk_mul_f32 v[66:67], v[54:55], v[220:221]
    v_pk_fma_f32 v[64:65], v[54:55], v[212:213], v[64:65]
    v_pk_fma_f32 v[66:67], v[62:63], v[212:213], v[66:67] neg_lo:[0,0,1] neg_hi:[0,0,1]
    v_cvt_pk_bf16_f32 v123, v64, v65
    v_cvt_pk_bf16_f32 v127, v66, v67
    s_nop 0
    v_mfma_f32_16x16x32_bf16 v[88:91], v[120:123], v[222:225], 0
    v_mfma_f32_16x16x32_bf16 v[92:95], v[120:123], v[230:233], 0
    v_mfma_f32_16x16x32_bf16 v[88:91], v[124:127], v[226:229], v[88:91]
    v_mfma_f32_16x16x32_bf16 v[92:95], v[124:127], v[234:237], v[92:95]
    s_add_u32 m0, s47, 94208
    s_waitcnt vmcnt(4)
    v_permlane16_swap_b32 v160, v162
    buffer_load_dwordx4 v242, s[4:7], m0 offen sc1 lds
    v_permlane16_swap_b32 v161, v163
    v_permlane16_swap_b32 v164, v166
    v_permlane16_swap_b32 v165, v167
    v_lshlrev_b32 v128, 16, v160
    v_and_b32 v129, 0xffff0000, v160
    v_lshlrev_b32 v130, 16, v161
    v_and_b32 v131, 0xffff0000, v161
    v_lshlrev_b32 v132, 16, v162
    v_and_b32 v133, 0xffff0000, v162
    v_lshlrev_b32 v134, 16, v163
    v_and_b32 v135, 0xffff0000, v163
    v_lshlrev_b32 v136, 16, v164
    v_and_b32 v137, 0xffff0000, v164
    v_lshlrev_b32 v138, 16, v165
    s_add_u32 m0, s47, 98304
    v_and_b32 v139, 0xffff0000, v165
    buffer_load_dwordx4 v242, s[4:7], m0 offen sc1 lds
    v_lshlrev_b32 v140, 16, v166
    v_and_b32 v141, 0xffff0000, v166
    v_lshlrev_b32 v142, 16, v167
    v_and_b32 v143, 0xffff0000, v167
    v_pk_add_f32 v[80:81], v[80:81], v[128:129]
    v_pk_add_f32 v[82:83], v[82:83], v[130:131]
    v_pk_add_f32 v[84:85], v[84:85], v[132:133]
    v_pk_add_f32 v[86:87], v[86:87], v[134:135]
    v_pk_add_f32 v[32:33], v[80:81], v[82:83]
    v_pk_mul_f32 v[34:35], v[80:81], v[80:81]
    v_pk_fma_f32 v[34:35], v[82:83], v[82:83], v[34:35]
    v_pk_add_f32 v[32:33], v[32:33], v[84:85]
    v_pk_fma_f32 v[34:35], v[84:85], v[84:85], v[34:35]
    v_pk_add_f32 v[32:33], v[32:33], v[86:87]
    v_pk_fma_f32 v[34:35], v[86:87], v[86:87], v[34:35]
    s_add_u32 m0, s47, 102400
    v_add_f32 v40, v32, v33
    buffer_load_dwordx4 v242, s[4:7], m0 offen sc1 lds
    v_add_f32 v41, v34, v35
    v_pk_add_f32 v[88:89], v[88:89], v[136:137]
    v_pk_add_f32 v[90:91], v[90:91], v[138:139]
    v_pk_add_f32 v[92:93], v[92:93], v[140:141]
    v_pk_add_f32 v[94:95], v[94:95], v[142:143]
    v_pk_add_f32 v[36:37], v[88:89], v[90:91]
    v_pk_mul_f32 v[38:39], v[88:89], v[88:89]
    v_pk_fma_f32 v[38:39], v[90:91], v[90:91], v[38:39]
    v_pk_add_f32 v[36:37], v[36:37], v[92:93]
    v_pk_fma_f32 v[38:39], v[92:93], v[92:93], v[38:39]
    v_pk_add_f32 v[36:37], v[36:37], v[94:95]
    v_pk_fma_f32 v[38:39], v[94:95], v[94:95], v[38:39]
    v_add_f32 v42, v36, v37
    v_add_f32 v43, v38, v39
    s_nop 0
    v_permlane32_swap_b32 v40, v42
    v_permlane32_swap_b32 v41, v43
    v_add_f32 v40, v40, v42
    v_add_f32 v41, v41, v43
    s_add_u32 m0, s47, 106496
    s_nop 0
    buffer_load_dwordx4 v242, s[4:7], m0 offen sc1 lds
    v_permlane16_swap_b32 v40, v41
    v_add_f32 v40, v40, v41
    s_nop 1
    v_add_f32_dpp v40, v40, v40 row_ror:8 row_mask:0xf bank_mask:0xf
    s_add_u32 m0, s47, 110592
    s_nop 0
    buffer_load_dwordx4 v242, s[4:7], m0 offen sc1 lds
    v_add_f32_dpp v40, v40, v40 row_ror:4 row_mask:0xf bank_mask:0xf
    s_nop 1
    v_add_f32_dpp v40, v40, v40 row_ror:2 row_mask:0xf bank_mask:0xf
    s_add_u32 m0, s47, 114688
    s_nop 0
    buffer_load_dwordx4 v242, s[4:7], m0 offen sc1 lds
    v_add_f32_dpp v40, v40, v40 row_ror:1 row_mask:0xf bank_mask:0xf
    v_mov_b32 v41, v40
    s_nop 1
    v_permlane16_swap_b32 v40, v41
    v_mul_f32 v40, s64, v40
    v_mul_f32 v45, v40, v40
    v_fma_f32 v41, v41, s64, -v45
    v_max_f32 v41, 0, v41
    v_add_f32 v41, 0x3727c5ac, v41
    v_rsq_f32 v44, v41
    s_nop 0
    v_mul_f32 v44, 0x3fb8aa3b, v44
    v_mul_f32 v45, v40, v44
    v_mov_b32 v48, v44
    v_mov_b32 v49, v45
    v_rcp_f32 v46, v44
    v_permlane32_swap_b32 v44, v48
    v_permlane32_swap_b32 v45, v49
    v_mov_b32 v47, v40
    v_pk_fma_f32 v[80:81], v[80:81], v[44:45], v[44:45] op_sel:[0,0,1] op_sel_hi:[1,0,1] neg_lo:[0,0,1] neg_hi:[0,0,1]
    v_cvt_pk_bf16_f32 v64, v80, v81
    v_pk_fma_f32 v[82:83], v[82:83], v[44:45], v[44:45] op_sel:[0,0,1] op_sel_hi:[1,0,1] neg_lo:[0,0,1] neg_hi:[0,0,1]
    v_cvt_pk_bf16_f32 v65, v82, v83
    ds_write_b64 v27, v[64:65] offset:0
    v_pk_fma_f32 v[84:85], v[84:85], v[44:45], v[44:45] op_sel:[0,0,1] op_sel_hi:[1,0,1] neg_lo:[0,0,1] neg_hi:[0,0,1]
    v_cvt_pk_bf16_f32 v66, v84, v85
    v_pk_fma_f32 v[86:87], v[86:87], v[44:45], v[44:45] op_sel:[0,0,1] op_sel_hi:[1,0,1] neg_lo:[0,0,1] neg_hi:[0,0,1]
    v_cvt_pk_bf16_f32 v67, v86, v87
    ds_write_b64 v27, v[66:67] offset:512
    v_pk_fma_f32 v[88:89], v[88:89], v[48:49], v[48:49] op_sel:[0,0,1] op_sel_hi:[1,0,1] neg_lo:[0,0,1] neg_hi:[0,0,1]
    v_cvt_pk_bf16_f32 v68, v88, v89
    v_pk_fma_f32 v[90:91], v[90:91], v[48:49], v[48:49] op_sel:[0,0,1] op_sel_hi:[1,0,1] neg_lo:[0,0,1] neg_hi:[0,0,1]
    v_cvt_pk_bf16_f32 v69, v90, v91
    ds_write_b64 v27, v[68:69] offset:1024
    v_pk_fma_f32 v[92:93], v[92:93], v[48:49], v[48:49] op_sel:[0,0,1] op_sel_hi:[1,0,1] neg_lo:[0,0,1] neg_hi:[0,0,1]
    v_cvt_pk_bf16_f32 v70, v92, v93
    v_pk_fma_f32 v[94:95], v[94:95], v[48:49], v[48:49] op_sel:[0,0,1] op_sel_hi:[1,0,1] neg_lo:[0,0,1] neg_hi:[0,0,1]
    v_cvt_pk_bf16_f32 v71, v94, v95
    ds_write_b64 v27, v[70:71] offset:1536
    s_mov_b32 exec_lo, 1
    s_mov_b32 exec_hi, 1
    buffer_store_dwordx2 v[46:47], v245, s[4:7], s0 offen sc1
    s_mov_b64 exec, -1
    s_waitcnt lgkmcnt(0)
    s_barrier
    ds_read_b128 v[48:51], v28
    ds_read_b128 v[52:55], v31 offset:128
    s_waitcnt lgkmcnt(1)
    buffer_store_dwordx4 v[48:51], v29, s[4:7], s73 offen sc1
    s_waitcnt lgkmcnt(0)
    buffer_store_dwordx4 v[52:55], v29, s[4:7], s73 offen offset:2048 sc1
    s_mov_b32 s44, s75
    s_add_u32 s45, s75, 16384
    s_add_u32 s82, s37, 1
    s_and_b32 s82, s82, 3
    s_mul_i32 s82, s82, 45056
    s_add_u32 s96, s79, s82
    s_add_u32 s82, s37, 2
    s_and_b32 s82, s82, 3
    s_mul_i32 s82, s82, 45056
    s_add_u32 s97, s79, s82
    s_add_u32 s82, s37, 3
    s_and_b32 s82, s82, 3
    s_mul_i32 s82, s82, 45056
    s_add_u32 s98, s79, s82
    s_add_u32 s82, s37, 4
    s_and_b32 s82, s82, 3
    s_mul_i32 s82, s82, 45056
    s_add_u32 s99, s79, s82
    s_lshl_b32 s82, s32, 1
    s_add_u32 s82, s82, s34
    s_add_u32 s82, s82, s35
    s_and_b32 s42, s82, 0
    s_mul_i32 s83, s42, 2816
    s_add_u32 s96, s96, s83
    s_add_u32 s97, s97, s83
    s_add_u32 s98, s98, s83
    s_add_u32 s99, s99, s83
    s_add_u32 s82, s42, 1
    s_cmp_eq_u32 s82, 4
    s_cselect_b32 s82, -3, 1
    s_mul_i32 s84, s82, 2816
    s_add_u32 s82, s42, 2
    s_cmp_eq_u32 s82, 4
    s_cselect_b32 s82, -3, 1
    s_mul_i32 s85, s82, 2816
    s_add_u32 s82, s42, 3
    s_cmp_eq_u32 s82, 4
    s_cselect_b32 s82, -3, 1
    s_mul_i32 s86, s82, 2816
    s_add_u32 s82, s42, 3
    s_and_b32 s82, s82, 3
    s_mul_i32 s87, s82, 2816
    s_mov_b32 s88, s83
    s_waitcnt vmcnt(0)
    s_mov_b64 exec, s[60:61]
    buffer_store_dword v30, off, s[4:7], s74 offset:0
    s_mov_b64 exec, s[62:63]
    buffer_store_dword v30, off, s[4:7], s74 offset:0 sc1
    s_mov_b64 exec, -1
    buffer_load_dword v240, v238, s[4:7], s76 offen offset:0 sc1
    s_waitcnt vmcnt(0)
    v_cmp_ne_u32 vcc, s28, v240
    s_cbranch_vccnz L_pC11_re
L_pC11_ok:
    buffer_load_dwordx4 a[176:179], v1, s[4:7], s44 offen offset:0 sc1
    buffer_load_dwordx4 a[180:183], v1, s[4:7], s45 offen offset:0 sc1
    buffer_load_dwordx4 a[184:187], v1, s[4:7], s44 offen offset:1024 sc1
    buffer_load_dwordx4 a[188:191], v1, s[4:7], s45 offen offset:1024 sc1
    buffer_load_dwordx4 a[192:195], v1, s[4:7], s44 offen offset:2048 sc1
    buffer_load_dwordx4 a[196:199], v1, s[4:7], s45 offen offset:2048 sc1
    buffer_load_dwordx4 a[200:203], v1, s[4:7], s44 offen offset:3072 sc1
    buffer_load_dwordx4 a[204:207], v1, s[4:7], s45 offen offset:3072 sc1
    s_add_u32 s44, s44, 4096
    buffer_load_dwordx4 a[208:211], v1, s[4:7], s44 offen offset:0 sc1
    s_add_u32 s45, s45, 4096
    buffer_load_dwordx4 a[212:215], v1, s[4:7], s45 offen offset:0 sc1
    s_barrier
    ds_read_b128 v[96:99], v1 offset:0
    ds_read_b128 v[100:103], v1 offset:1024
    ds_read_b128 v[104:107], v1 offset:2048
    ds_read_b128 v[108:111], v1 offset:3072
    ds_read_b128 v[112:115], v1 offset:4096
    ds_read_b128 v[116:119], v1 offset:5120
    s_waitcnt vmcnt(8) lgkmcnt(5)
    v_mfma_f32_16x16x32_bf16 v[32:35], v[96:99], a[176:179], 0
    ds_read_b128 v[120:123], v1 offset:6144
    v_mfma_f32_16x16x32_bf16 v[36:39], v[96:99], a[180:183], 0
    s_waitcnt lgkmcnt(5)
    buffer_load_dwordx4 a[216:219], v1, s[4:7], s44 offen offset:1024 sc1
    v_mfma_f32_16x16x32_bf16 v[40:43], v[100:103], a[176:179], 0
    ds_read_b128 v[124:127], v1 offset:7168
    v_mfma_f32_16x16x32_bf16 v[44:47], v[100:103], a[180:183], 0
    s_waitcnt lgkmcnt(5)
    v_mfma_f32_16x16x32_bf16 v[48:51], v[104:107], a[176:179], 0
    ds_read_b128 v[96:99], v1 offset:8192
    v_mfma_f32_16x16x32_bf16 v[52:55], v[104:107], a[180:183], 0
    s_waitcnt lgkmcnt(5)
    buffer_load_dwordx4 a[220:223], v1, s[4:7], s45 offen offset:1024 sc1
    v_mfma_f32_16x16x32_bf16 v[56:59], v[108:111], a[176:179], 0
    ds_read_b128 v[100:103], v1 offset:9216
    v_mfma_f32_16x16x32_bf16 v[60:63], v[108:111], a[180:183], 0
    s_waitcnt vmcnt(8) lgkmcnt(5)
    v_mfma_f32_16x16x32_bf16 v[32:35], v[112:115], a[184:187], v[32:35]
    ds_read_b128 v[104:107], v1 offset:10240
    v_mfma_f32_16x16x32_bf16 v[36:39], v[112:115], a[188:191], v[36:39]
    s_waitcnt lgkmcnt(5)
    buffer_load_dwordx4 a[224:227], v1, s[4:7], s44 offen offset:2048 sc1
    v_mfma_f32_16x16x32_bf16 v[40:43], v[116:119], a[184:187], v[40:43]
    ds_read_b128 v[108:111], v1 offset:11264
    v_mfma_f32_16x16x32_bf16 v[44:47], v[116:119], a[188:191], v[44:47]
    s_waitcnt lgkmcnt(5)
    v_mfma_f32_16x16x32_bf16 v[48:51], v[120:123], a[184:187], v[48:51]
    ds_read_b128 v[112:115], v1 offset:12288
    v_mfma_f32_16x16x32_bf16 v[52:55], v[120:123], a[188:191], v[52:55]
    s_waitcnt lgkmcnt(5)
    buffer_load_dwordx4 a[228:231], v1, s[4:7], s45 offen offset:2048 sc1
    v_mfma_f32_16x16x32_bf16 v[56:59], v[124:127], a[184:187], v[56:59]
    ds_read_b128 v[116:119], v1 offset:13312
    v_mfma_f32_16x16x32_bf16 v[60:63], v[124:127], a[188:191], v[60:63]
    s_waitcnt vmcnt(8) lgkmcnt(5)
    v_mfma_f32_16x16x32_bf16 v[32:35], v[96:99], a[192:195], v[32:35]
    ds_read_b128 v[120:123], v1 offset:14336
    v_mfma_f32_16x16x32_bf16 v[36:39], v[96:99], a[196:199], v[36:39]
    s_waitcnt lgkmcnt(5)
    buffer_load_dwordx4 a[232:235], v1, s[4:7], s44 offen offset:3072 sc1
    v_mfma_f32_16x16x32_bf16 v[40:43], v[100:103], a[192:195], v[40:43]
    ds_read_b128 v[124:127], v1 offset:15360
    v_mfma_f32_16x16x32_bf16 v[44:47], v[100:103], a[196:199], v[44:47]
    s_waitcnt lgkmcnt(5)
    v_mfma_f32_16x16x32_bf16 v[48:51], v[104:107], a[192:195], v[48:51]
    ds_read_b128 v[96:99], v1 offset:16384
    v_mfma_f32_16x16x32_bf16 v[52:55], v[104:107], a[196:199], v[52:55]
    s_waitcnt lgkmcnt(5)
    buffer_load_dwordx4 a[236:239], v1, s[4:7], s45 offen offset:3072 sc1
    v_mfma_f32_16x16x32_bf16 v[56:59], v[108:111], a[192:195], v[56:59]
    s_add_u32 s44, s44, 4096
    ds_read_b128 v[100:103], v1 offset:17408
    v_mfma_f32_16x16x32_bf16 v[60:63], v[108:111], a[196:199], v[60:63]
    s_waitcnt vmcnt(8) lgkmcnt(5)
    v_mfma_f32_16x16x32_bf16 v[32:35], v[112:115], a[200:203], v[32:35]
    ds_read_b128 v[104:107], v1 offset:18432
    v_mfma_f32_16x16x32_bf16 v[36:39], v[112:115], a[204:207], v[36:39]
    s_waitcnt lgkmcnt(5)
    buffer_load_dwordx4 a[240:243], v1, s[4:7], s44 offen offset:0 sc1
    v_mfma_f32_16x16x32_bf16 v[40:43], v[116:119], a[200:203], v[40:43]
    s_add_u32 s45, s45, 4096
    ds_read_b128 v[108:111], v1 offset:19456
    v_mfma_f32_16x16x32_bf16 v[44:47], v[116:119], a[204:207], v[44:47]
    s_waitcnt lgkmcnt(5)
    v_mfma_f32_16x16x32_bf16 v[48:51], v[120:123], a[200:203], v[48:51]
    ds_read_b128 v[112:115], v1 offset:20480
    v_mfma_f32_16x16x32_bf16 v[52:55], v[120:123], a[204:207], v[52:55]
    s_waitcnt lgkmcnt(5)
    buffer_load_dwordx4 a[244:247], v1, s[4:7], s45 offen offset:0 sc1
    v_mfma_f32_16x16x32_bf16 v[56:59], v[124:127], a[200:203], v[56:59]
    ds_read_b128 v[116:119], v1 offset:21504
    v_mfma_f32_16x16x32_bf16 v[60:63], v[124:127], a[204:207], v[60:63]
    s_waitcnt vmcnt(8) lgkmcnt(5)
    v_mfma_f32_16x16x32_bf16 v[32:35], v[96:99], a[208:211], v[32:35]
    ds_read_b128 v[120:123], v1 offset:22528
    v_mfma_f32_16x16x32_bf16 v[36:39], v[96:99], a[212:215], v[36:39]
    s_waitcnt lgkmcnt(5)
    buffer_load_dwordx4 a[248:251], v1, s[4:7], s44 offen offset:1024 sc1
    v_mfma_f32_16x16x32_bf16 v[40:43], v[100:103], a[208:211], v[40:43]
    ds_read_b128 v[124:127], v1 offset:23552
    v_mfma_f32_16x16x32_bf16 v[44:47], v[100:103], a[212:215], v[44:47]
    s_waitcnt lgkmcnt(5)
    v_mfma_f32_16x16x32_bf16 v[48:51], v[104:107], a[208:211], v[48:51]
    ds_read_b128 v[96:99], v1 offset:24576
    v_mfma_f32_16x16x32_bf16 v[52:55], v[104:107], a[212:215], v[52:55]
    s_waitcnt lgkmcnt(5)
    buffer_load_dwordx4 a[252:255], v1, s[4:7], s45 offen offset:1024 sc1
    v_mfma_f32_16x16x32_bf16 v[56:59], v[108:111], a[208:211], v[56:59]
    ds_read_b128 v[100:103], v1 offset:25600
    v_mfma_f32_16x16x32_bf16 v[60:63], v[108:111], a[212:215], v[60:63]
    s_waitcnt vmcnt(8) lgkmcnt(5)
    v_mfma_f32_16x16x32_bf16 v[32:35], v[112:115], a[216:219], v[32:35]
    ds_read_b128 v[104:107], v1 offset:26624
    v_mfma_f32_16x16x32_bf16 v[36:39], v[112:115], a[220:223], v[36:39]
    s_waitcnt lgkmcnt(5)
    buffer_load_dwordx4 v[128:131], v1, s[4:7], s44 offen offset:2048 sc1
    v_mfma_f32_16x16x32_bf16 v[40:43], v[116:119], a[216:219], v[40:43]
    ds_read_b128 v[108:111], v1 offset:27648
    v_mfma_f32_16x16x32_bf16 v[44:47], v[116:119], a[220:223], v[44:47]
    s_waitcnt lgkmcnt(5)
    v_mfma_f32_16x16x32_bf16 v[48:51], v[120:123], a[216:219], v[48:51]
    ds_read_b128 v[112:115], v1 offset:28672
    v_mfma_f32_16x16x32_bf16 v[52:55], v[120:123], a[220:223], v[52:55]
    s_waitcnt lgkmcnt(5)
    buffer_load_dwordx4 v[132:135], v1, s[4:7], s45 offen offset:2048 sc1
    v_mfma_f32_16x16x32_bf16 v[56:59], v[124:127], a[216:219], v[56:59]
    ds_read_b128 v[116:119], v1 offset:29696
    v_mfma_f32_16x16x32_bf16 v[60:63], v[124:127], a[220:223], v[60:63]
    s_waitcnt vmcnt(8) lgkmcnt(5)
    v_mfma_f32_16x16x32_bf16 v[32:35], v[96:99], a[224:227], v[32:35]
    ds_read_b128 v[120:123], v1 offset:30720
    v_mfma_f32_16x16x32_bf16 v[36:39], v[96:99], a[228:231], v[36:39]
    s_waitcnt lgkmcnt(5)
    buffer_load_dwordx4 v[136:139], v1, s[4:7], s44 offen offset:3072 sc1
    v_mfma_f32_16x16x32_bf16 v[40:43], v[100:103], a[224:227], v[40:43]
    ds_read_b128 v[124:127], v1 offset:31744
    v_mfma_f32_16x16x32_bf16 v[44:47], v[100:103], a[228:231], v[44:47]
    s_waitcnt lgkmcnt(5)
    v_mfma_f32_16x16x32_bf16 v[48:51], v[104:107], a[224:227], v[48:51]
    ds_read_b128 v[96:99], v1 offset:32768
    v_mfma_f32_16x16x32_bf16 v[52:55], v[104:107], a[228:231], v[52:55]
    s_waitcnt lgkmcnt(5)
    buffer_load_dwordx4 v[140:143], v1, s[4:7], s45 offen offset:3072 sc1
    v_mfma_f32_16x16x32_bf16 v[56:59], v[108:111], a[224:227], v[56:59]
    s_add_u32 s44, s44, 4096
    ds_read_b128 v[100:103], v1 offset:33792
    v_mfma_f32_16x16x32_bf16 v[60:63], v[108:111], a[228:231], v[60:63]
    s_waitcnt vmcnt(8) lgkmcnt(5)
    v_mfma_f32_16x16x32_bf16 v[32:35], v[112:115], a[232:235], v[32:35]
    ds_read_b128 v[104:107], v1 offset:34816
    v_mfma_f32_16x16x32_bf16 v[36:39], v[112:115], a[236:239], v[36:39]
    s_waitcnt lgkmcnt(5)
    buffer_load_dwordx4 v[144:147], v1, s[4:7], s44 offen offset:0 sc1
    v_mfma_f32_16x16x32_bf16 v[40:43], v[116:119], a[232:235], v[40:43]
    s_add_u32 s45, s45, 4096
    ds_read_b128 v[108:111], v1 offset:35840
    v_mfma_f32_16x16x32_bf16 v[44:47], v[116:119], a[236:239], v[44:47]
    s_waitcnt lgkmcnt(5)
    v_mfma_f32_16x16x32_bf16 v[48:51], v[120:123], a[232:235], v[48:51]
    ds_read_b128 v[112:115], v1 offset:36864
    v_mfma_f32_16x16x32_bf16 v[52:55], v[120:123], a[236:239], v[52:55]
    s_waitcnt lgkmcnt(5)
    buffer_load_dwordx4 v[148:151], v1, s[4:7], s45 offen offset:0 sc1
    v_mfma_f32_16x16x32_bf16 v[56:59], v[124:127], a[232:235], v[56:59]
    ds_read_b128 v[116:119], v1 offset:37888
    v_mfma_f32_16x16x32_bf16 v[60:63], v[124:127], a[236:239], v[60:63]
    s_waitcnt vmcnt(8) lgkmcnt(5)
    v_mfma_f32_16x16x32_bf16 v[32:35], v[96:99], a[240:243], v[32:35]
    ds_read_b128 v[120:123], v1 offset:38912
    v_mfma_f32_16x16x32_bf16 v[36:39], v[96:99], a[244:247], v[36:39]
    s_waitcnt lgkmcnt(5)
    buffer_load_dwordx4 v[152:155], v1, s[4:7], s44 offen offset:1024 sc1
    v_mfma_f32_16x16x32_bf16 v[40:43], v[100:103], a[240:243], v[40:43]
    ds_read_b128 v[124:127], v1 offset:39936
    v_mfma_f32_16x16x32_bf16 v[44:47], v[100:103], a[244:247], v[44:47]
    s_waitcnt lgkmcnt(5)
    v_mfma_f32_16x16x32_bf16 v[48:51], v[104:107], a[240:243], v[48:51]
    ds_read_b128 v[96:99], v1 offset:40960
    v_mfma_f32_16x16x32_bf16 v[52:55], v[104:107], a[244:247], v[52:55]
    s_waitcnt lgkmcnt(5)
    buffer_load_dwordx4 v[156:159], v1, s[4:7], s45 offen offset:1024 sc1
    v_mfma_f32_16x16x32_bf16 v[56:59], v[108:111], a[240:243], v[56:59]
    ds_read_b128 v[100:103], v1 offset:41984
    v_mfma_f32_16x16x32_bf16 v[60:63], v[108:111], a[244:247], v[60:63]
    s_waitcnt vmcnt(8) lgkmcnt(5)
    v_mfma_f32_16x16x32_bf16 v[32:35], v[112:115], a[248:251], v[32:35]
    ds_read_b128 v[104:107], v1 offset:43008
    v_mfma_f32_16x16x32_bf16 v[36:39], v[112:115], a[252:255], v[36:39]
    s_waitcnt lgkmcnt(5)
    buffer_load_dwordx4 v[160:163], v1, s[4:7], s44 offen offset:2048 sc1
    v_mfma_f32_16x16x32_bf16 v[40:43], v[116:119], a[248:251], v[40:43]
    ds_read_b128 v[108:111], v1 offset:44032
    v_mfma_f32_16x16x32_bf16 v[44:47], v[116:119], a[252:255], v[44:47]
    s_waitcnt lgkmcnt(5)
    v_mfma_f32_16x16x32_bf16 v[48:51], v[120:123], a[248:251], v[48:51]
    ds_read_b128 v[112:115], v1 offset:45056
    v_mfma_f32_16x16x32_bf16 v[52:55], v[120:123], a[252:255], v[52:55]
    s_waitcnt lgkmcnt(5)
    buffer_load_dwordx4 v[164:167], v1, s[4:7], s45 offen offset:2048 sc1
    v_mfma_f32_16x16x32_bf16 v[56:59], v[124:127], a[248:251], v[56:59]
    ds_read_b128 v[116:119], v1 offset:46080
    v_mfma_f32_16x16x32_bf16 v[60:63], v[124:127], a[252:255], v[60:63]
    s_waitcnt vmcnt(8) lgkmcnt(5)
    v_mfma_f32_16x16x32_bf16 v[32:35], v[96:99], v[128:131], v[32:35]
    ds_read_b128 v[120:123], v1 offset:47104
    v_mfma_f32_16x16x32_bf16 v[36:39], v[96:99], v[132:135], v[36:39]
    s_waitcnt lgkmcnt(5)
    buffer_load_dwordx4 v[168:171], v1, s[4:7], s44 offen offset:3072 sc1
    v_mfma_f32_16x16x32_bf16 v[40:43], v[100:103], v[128:131], v[40:43]
    ds_read_b128 v[124:127], v1 offset:48128
    v_mfma_f32_16x16x32_bf16 v[44:47], v[100:103], v[132:135], v[44:47]
    s_waitcnt lgkmcnt(5)
    v_mfma_f32_16x16x32_bf16 v[48:51], v[104:107], v[128:131], v[48:51]
    ds_read_b128 v[96:99], v1 offset:49152
    v_mfma_f32_16x16x32_bf16 v[52:55], v[104:107], v[132:135], v[52:55]
    s_waitcnt lgkmcnt(5)
    buffer_load_dwordx4 v[172:175], v1, s[4:7], s45 offen offset:3072 sc1
    v_mfma_f32_16x16x32_bf16 v[56:59], v[108:111], v[128:131], v[56:59]
    s_add_u32 m0, s47, 118784
    ds_read_b128 v[100:103], v1 offset:50176
    v_mfma_f32_16x16x32_bf16 v[60:63], v[108:111], v[132:135], v[60:63]
    s_waitcnt vmcnt(8) lgkmcnt(5)
    v_mfma_f32_16x16x32_bf16 v[32:35], v[112:115], v[136:139], v[32:35]
    ds_read_b128 v[104:107], v1 offset:51200
    v_mfma_f32_16x16x32_bf16 v[36:39], v[112:115], v[140:143], v[36:39]
    s_waitcnt lgkmcnt(5)
    buffer_load_dwordx4 v242, s[4:7], m0 offen sc1 lds
    v_mfma_f32_16x16x32_bf16 v[40:43], v[116:119], v[136:139], v[40:43]
    s_add_u32 m0, s47, 122880
    ds_read_b128 v[108:111], v1 offset:52224
    v_mfma_f32_16x16x32_bf16 v[44:47], v[116:119], v[140:143], v[44:47]
    s_waitcnt lgkmcnt(5)
    v_mfma_f32_16x16x32_bf16 v[48:51], v[120:123], v[136:139], v[48:51]
    ds_read_b128 v[112:115], v1 offset:53248
    v_mfma_f32_16x16x32_bf16 v[52:55], v[120:123], v[140:143], v[52:55]
    s_waitcnt lgkmcnt(5)
    buffer_load_dwordx4 v242, s[4:7], m0 offen sc1 lds
    v_mfma_f32_16x16x32_bf16 v[56:59], v[124:127], v[136:139], v[56:59]
    s_add_u32 m0, s47, 126976
    ds_read_b128 v[116:119], v1 offset:54272
    v_mfma_f32_16x16x32_bf16 v[60:63], v[124:127], v[140:143], v[60:63]
    s_waitcnt vmcnt(8) lgkmcnt(5)
    v_mfma_f32_16x16x32_bf16 v[32:35], v[96:99], v[144:147], v[32:35]
    ds_read_b128 v[120:123], v1 offset:55296
    v_mfma_f32_16x16x32_bf16 v[36:39], v[96:99], v[148:151], v[36:39]
    s_waitcnt lgkmcnt(5)
    buffer_load_dwordx4 v242, s[4:7], m0 offen sc1 lds
    v_mfma_f32_16x16x32_bf16 v[40:43], v[100:103], v[144:147], v[40:43]
    s_add_u32 m0, s47, 131072
    ds_read_b128 v[124:127], v1 offset:56320
    v_mfma_f32_16x16x32_bf16 v[44:47], v[100:103], v[148:151], v[44:47]
    s_waitcnt lgkmcnt(5)
    v_mfma_f32_16x16x32_bf16 v[48:51], v[104:107], v[144:147], v[48:51]
    ds_read_b128 v[96:99], v1 offset:57344
    v_mfma_f32_16x16x32_bf16 v[52:55], v[104:107], v[148:151], v[52:55]
    s_waitcnt lgkmcnt(5)
    buffer_load_dwordx4 v242, s[4:7], m0 offen sc1 lds
    v_mfma_f32_16x16x32_bf16 v[56:59], v[108:111], v[144:147], v[56:59]
    s_add_u32 m0, s47, 135168
    ds_read_b128 v[100:103], v1 offset:58368
    v_mfma_f32_16x16x32_bf16 v[60:63], v[108:111], v[148:151], v[60:63]
    s_waitcnt vmcnt(8) lgkmcnt(5)
    v_mfma_f32_16x16x32_bf16 v[32:35], v[112:115], v[152:155], v[32:35]
    ds_read_b128 v[104:107], v1 offset:59392
    v_mfma_f32_16x16x32_bf16 v[36:39], v[112:115], v[156:159], v[36:39]
    s_waitcnt lgkmcnt(5)
    buffer_load_dwordx4 v242, s[4:7], m0 offen sc1 lds
    v_mfma_f32_16x16x32_bf16 v[40:43], v[116:119], v[152:155], v[40:43]
    s_add_u32 m0, s47, 139264
    ds_read_b128 v[108:111], v1 offset:60416
    v_mfma_f32_16x16x32_bf16 v[44:47], v[116:119], v[156:159], v[44:47]
    s_waitcnt lgkmcnt(5)
    v_mfma_f32_16x16x32_bf16 v[48:51], v[120:123], v[152:155], v[48:51]
    ds_read_b128 v[112:115], v1 offset:61440
    v_mfma_f32_16x16x32_bf16 v[52:55], v[120:123], v[156:159], v[52:55]
    s_waitcnt lgkmcnt(5)
    buffer_load_dwordx4 v242, s[4:7], m0 offen sc1 lds
    v_mfma_f32_16x16x32_bf16 v[56:59], v[124:127], v[152:155], v[56:59]
    s_add_u32 m0, s47, 143360
    ds_read_b128 v[116:119], v1 offset:62464
    v_mfma_f32_16x16x32_bf16 v[60:63], v[124:127], v[156:159], v[60:63]
    s_waitcnt vmcnt(8) lgkmcnt(5)
    v_mfma_f32_16x16x32_bf16 v[32:35], v[96:99], v[160:163], v[32:35]
    ds_read_b128 v[120:123], v1 offset:63488
    v_mfma_f32_16x16x32_bf16 v[36:39], v[96:99], v[164:167], v[36:39]
    s_waitcnt lgkmcnt(5)
    buffer_load_dwordx4 v242, s[4:7], m0 offen sc1 lds
    v_mfma_f32_16x16x32_bf16 v[40:43], v[100:103], v[160:163], v[40:43]
    s_add_u32 m0, s47, 147456
    ds_read_b128 v[124:127], v1 offset:64512
    v_mfma_f32_16x16x32_bf16 v[44:47], v[100:103], v[164:167], v[44:47]
    s_waitcnt lgkmcnt(5)
    v_mfma_f32_16x16x32_bf16 v[48:51], v[104:107], v[160:163], v[48:51]
    ds_read_b128 v[96:99], v10 offset:0
    v_mfma_f32_16x16x32_bf16 v[52:55], v[104:107], v[164:167], v[52:55]
    s_waitcnt lgkmcnt(5)
    buffer_load_dwordx4 v242, s[4:7], m0 offen sc1 lds
    v_mfma_f32_16x16x32_bf16 v[56:59], v[108:111], v[160:163], v[56:59]
    s_add_u32 m0, s47, 151552
    ds_read_b128 v[100:103], v10 offset:1024
    v_mfma_f32_16x16x32_bf16 v[60:63], v[108:111], v[164:167], v[60:63]
    s_waitcnt vmcnt(8) lgkmcnt(5)
    v_mfma_f32_16x16x32_bf16 v[32:35], v[112:115], v[168:171], v[32:35]
    ds_read_b128 v[104:107], v10 offset:2048
    v_mfma_f32_16x16x32_bf16 v[36:39], v[112:115], v[172:175], v[36:39]
    s_waitcnt lgkmcnt(5)
    buffer_load_dwordx4 v242, s[4:7], m0 offen sc1 lds
    v_mfma_f32_16x16x32_bf16 v[40:43], v[116:119], v[168:171], v[40:43]
    s_add_u32 m0, s47, 155648
    ds_read_b128 v[108:111], v10 offset:3072
    v_mfma_f32_16x16x32_bf16 v[44:47], v[116:119], v[172:175], v[44:47]
    s_waitcnt lgkmcnt(5)
    v_mfma_f32_16x16x32_bf16 v[48:51], v[120:123], v[168:171], v[48:51]
    ds_read_b128 v[112:115], v10 offset:4096
    v_mfma_f32_16x16x32_bf16 v[52:55], v[120:123], v[172:175], v[52:55]
    s_waitcnt lgkmcnt(5)
    buffer_load_dwordx4 v242, s[4:7], m0 offen sc1 lds
    v_mfma_f32_16x16x32_bf16 v[56:59], v[124:127], v[168:171], v[56:59]
    s_add_u32 m0, s47, 159744
    ds_read_b128 v[116:119], v10 offset:5120
    v_mfma_f32_16x16x32_bf16 v[60:63], v[124:127], v[172:175], v[60:63]
    s_waitcnt lgkmcnt(5)
    v_mfma_f32_16x16x32_bf16 v[64:67], v[96:99], a[176:179], 0
    ds_read_b128 v[120:123], v10 offset:6144
    v_mfma_f32_16x16x32_bf16 v[68:71], v[96:99], a[180:183], 0
    s_waitcnt lgkmcnt(5)
    buffer_load_dwordx4 v242, s[4:7], m0 offen sc1 lds
    v_mfma_f32_16x16x32_bf16 v[72:75], v[100:103], a[176:179], 0
    ds_read_b128 v[124:127], v10 offset:7168
    v_mfma_f32_16x16x32_bf16 v[76:79], v[100:103], a[180:183], 0
    s_waitcnt lgkmcnt(5)
    v_mfma_f32_16x16x32_bf16 v[80:83], v[104:107], a[176:179], 0
    ds_read_b128 v[96:99], v10 offset:8192
    v_mfma_f32_16x16x32_bf16 v[84:87], v[104:107], a[180:183], 0
    s_waitcnt lgkmcnt(5)
    v_exp_f32 v184, -v32
    v_mfma_f32_16x16x32_bf16 v[64:67], v[108:111], a[184:187], v[64:67]
    ds_read_b128 v[100:103], v10 offset:9216
    v_mul_f32 v32, v32, v34
    v_mfma_f32_16x16x32_bf16 v[68:71], v[108:111], a[188:191], v[68:71]
    s_waitcnt lgkmcnt(5)
    v_exp_f32 v185, -v33
    v_mfma_f32_16x16x32_bf16 v[72:75], v[112:115], a[184:187], v[72:75]
    ds_read_b128 v[104:107], v10 offset:10240
    v_mul_f32 v33, v33, v35
    v_mfma_f32_16x16x32_bf16 v[76:79], v[112:115], a[188:191], v[76:79]
    s_waitcnt lgkmcnt(5)
    v_exp_f32 v186, -v40
    v_mfma_f32_16x16x32_bf16 v[80:83], v[116:119], a[184:187], v[80:83]
    ds_read_b128 v[108:111], v10 offset:11264
    v_fma_f32 v184, v184, s65, s65
    v_mfma_f32_16x16x32_bf16 v[84:87], v[116:119], a[188:191], v[84:87]
    s_waitcnt lgkmcnt(5)
    v_rcp_f32 v184, v184
    v_mfma_f32_16x16x32_bf16 v[64:67], v[120:123], a[192:195], v[64:67]
    ds_read_b128 v[112:115], v10 offset:12288
    v_fma_f32 v185, v185, s65, s65
    v_mfma_f32_16x16x32_bf16 v[68:71], v[120:123], a[196:199], v[68:71]
    s_waitcnt lgkmcnt(5)
    v_rcp_f32 v185, v185
    v_mfma_f32_16x16x32_bf16 v[72:75], v[124:127], a[192:195], v[72:75]
    ds_read_b128 v[116:119], v10 offset:13312
    v_mul_f32 v32, v32, v184
    v_mfma_f32_16x16x32_bf16 v[76:79], v[124:127], a[196:199], v[76:79]
    s_waitcnt lgkmcnt(5)
    v_exp_f32 v187, -v41
    v_mfma_f32_16x16x32_bf16 v[80:83], v[96:99], a[192:195], v[80:83]
    ds_read_b128 v[120:123], v10 offset:14336
    v_mul_f32 v33, v33, v185
    v_mfma_f32_16x16x32_bf16 v[84:87], v[96:99], a[196:199], v[84:87]
    s_waitcnt lgkmcnt(5)
    v_exp_f32 v188, -v48
    v_mfma_f32_16x16x32_bf16 v[64:67], v[100:103], a[200:203], v[64:67]
    ds_read_b128 v[124:127], v10 offset:15360
    v_cvt_pk_bf16_f32 v176, v32, v33
    v_mfma_f32_16x16x32_bf16 v[68:71], v[100:103], a[204:207], v[68:71]
    s_waitcnt lgkmcnt(5)
    v_exp_f32 v189, -v49
    v_mfma_f32_16x16x32_bf16 v[72:75], v[104:107], a[200:203], v[72:75]
    ds_read_b128 v[96:99], v10 offset:16384
    v_mul_f32 v40, v40, v42
    v_mfma_f32_16x16x32_bf16 v[76:79], v[104:107], a[204:207], v[76:79]
    s_waitcnt lgkmcnt(5)
    v_exp_f32 v184, -v56
    v_mfma_f32_16x16x32_bf16 v[80:83], v[108:111], a[200:203], v[80:83]
    ds_read_b128 v[100:103], v10 offset:17408
    v_mul_f32 v41, v41, v43
    v_mfma_f32_16x16x32_bf16 v[84:87], v[108:111], a[204:207], v[84:87]
    s_waitcnt lgkmcnt(5)
    v_exp_f32 v185, -v57
    v_mfma_f32_16x16x32_bf16 v[64:67], v[112:115], a[208:211], v[64:67]
    ds_read_b128 v[104:107], v10 offset:18432
    v_fma_f32 v186, v186, s65, s65
    v_mfma_f32_16x16x32_bf16 v[68:71], v[112:115], a[212:215], v[68:71]
    s_waitcnt lgkmcnt(5)
    v_rcp_f32 v186, v186
    v_mfma_f32_16x16x32_bf16 v[72:75], v[116:119], a[208:211], v[72:75]
    ds_read_b128 v[108:111], v10 offset:19456
    v_fma_f32 v187, v187, s65, s65
    v_mfma_f32_16x16x32_bf16 v[76:79], v[116:119], a[212:215], v[76:79]
    s_waitcnt lgkmcnt(5)
    v_rcp_f32 v187, v187
    v_mfma_f32_16x16x32_bf16 v[80:83], v[120:123], a[208:211], v[80:83]
    ds_read_b128 v[112:115], v10 offset:20480
    v_mul_f32 v40, v40, v186
    v_mfma_f32_16x16x32_bf16 v[84:87], v[120:123], a[212:215], v[84:87]
    s_waitcnt lgkmcnt(5)
    v_mul_f32 v41, v41, v187
    v_mul_f32 v48, v48, v50
    v_mfma_f32_16x16x32_bf16 v[64:67], v[124:127], a[216:219], v[64:67]
    ds_read_b128 v[116:119], v10 offset:21504
    v_cvt_pk_bf16_f32 v177, v40, v41
    v_mfma_f32_16x16x32_bf16 v[68:71], v[124:127], a[220:223], v[68:71]
    s_waitcnt lgkmcnt(5)
    v_exp_f32 v186, -v36
    v_mfma_f32_16x16x32_bf16 v[72:75], v[96:99], a[216:219], v[72:75]
    ds_read_b128 v[120:123], v10 offset:22528
    v_mul_f32 v49, v49, v51
    v_mfma_f32_16x16x32_bf16 v[76:79], v[96:99], a[220:223], v[76:79]
    s_waitcnt lgkmcnt(5)
    v_exp_f32 v187, -v37
    v_mfma_f32_16x16x32_bf16 v[80:83], v[100:103], a[216:219], v[80:83]
    ds_read_b128 v[124:127], v10 offset:23552
    v_fma_f32 v188, v188, s65, s65
    v_mfma_f32_16x16x32_bf16 v[84:87], v[100:103], a[220:223], v[84:87]
    s_waitcnt lgkmcnt(5)
    v_rcp_f32 v188, v188
    v_mfma_f32_16x16x32_bf16 v[64:67], v[104:107], a[224:227], v[64:67]
    ds_read_b128 v[96:99], v10 offset:24576
    v_fma_f32 v189, v189, s65, s65
    v_mfma_f32_16x16x32_bf16 v[68:71], v[104:107], a[228:231], v[68:71]
    s_waitcnt lgkmcnt(5)
    v_rcp_f32 v189, v189
    v_mfma_f32_16x16x32_bf16 v[72:75], v[108:111], a[224:227], v[72:75]
    ds_read_b128 v[100:103], v10 offset:25600
    v_mul_f32 v48, v48, v188
    v_mfma_f32_16x16x32_bf16 v[76:79], v[108:111], a[228:231], v[76:79]
    s_waitcnt lgkmcnt(5)
    v_mul_f32 v49, v49, v189
    v_mul_f32 v56, v56, v58
    v_mfma_f32_16x16x32_bf16 v[80:83], v[112:115], a[224:227], v[80:83]
    ds_read_b128 v[104:107], v10 offset:26624
    v_cvt_pk_bf16_f32 v178, v48, v49
    v_mfma_f32_16x16x32_bf16 v[84:87], v[112:115], a[228:231], v[84:87]
    s_waitcnt lgkmcnt(5)
    v_exp_f32 v188, -v44
    v_mfma_f32_16x16x32_bf16 v[64:67], v[116:119], a[232:235], v[64:67]
    ds_read_b128 v[108:111], v10 offset:27648
    v_mul_f32 v57, v57, v59
    v_mfma_f32_16x16x32_bf16 v[68:71], v[116:119], a[236:239], v[68:71]
    s_waitcnt lgkmcnt(5)
    v_exp_f32 v189, -v45
    v_mfma_f32_16x16x32_bf16 v[72:75], v[120:123], a[232:235], v[72:75]
    ds_read_b128 v[112:115], v10 offset:28672
    v_fma_f32 v184, v184, s65, s65
    v_mfma_f32_16x16x32_bf16 v[76:79], v[120:123], a[236:239], v[76:79]
    s_waitcnt lgkmcnt(5)
    v_rcp_f32 v184, v184
    v_mfma_f32_16x16x32_bf16 v[80:83], v[124:127], a[232:235], v[80:83]
    ds_read_b128 v[116:119], v10 offset:29696
    v_fma_f32 v185, v185, s65, s65
    v_mfma_f32_16x16x32_bf16 v[84:87], v[124:127], a[236:239], v[84:87]
    s_waitcnt lgkmcnt(5)
    v_rcp_f32 v185, v185
    v_mfma_f32_16x16x32_bf16 v[64:67], v[96:99], a[240:243], v[64:67]
    ds_read_b128 v[120:123], v10 offset:30720
    v_mul_f32 v56, v56, v184
    v_mfma_f32_16x16x32_bf16 v[68:71], v[96:99], a[244:247], v[68:71]
    s_waitcnt lgkmcnt(5)
    v_mul_f32 v57, v57, v185
    v_mul_f32 v36, v36, v38
    v_mfma_f32_16x16x32_bf16 v[72:75], v[100:103], a[240:243], v[72:75]
    ds_read_b128 v[124:127], v10 offset:31744
    v_cvt_pk_bf16_f32 v179, v56, v57
    v_mfma_f32_16x16x32_bf16 v[76:79], v[100:103], a[244:247], v[76:79]
    s_waitcnt lgkmcnt(5)
    buffer_store_dwordx4 v[176:179], v1, s[4:7], s78 offen offset:0 sc1
    v_mfma_f32_16x16x32_bf16 v[80:83], v[104:107], a[240:243], v[80:83]
    ds_read_b128 v[96:99], v10 offset:32768
    v_mul_f32 v37, v37, v39
    v_mfma_f32_16x16x32_bf16 v[84:87], v[104:107], a[244:247], v[84:87]
    s_waitcnt lgkmcnt(5)
    v_exp_f32 v184, -v52
    v_mfma_f32_16x16x32_bf16 v[64:67], v[108:111], a[248:251], v[64:67]
    ds_read_b128 v[100:103], v10 offset:33792
    v_fma_f32 v186, v186, s65, s65
    v_mfma_f32_16x16x32_bf16 v[68:71], v[108:111], a[252:255], v[68:71]
    s_waitcnt lgkmcnt(5)
    v_rcp_f32 v186, v186
    v_mfma_f32_16x16x32_bf16 v[72:75], v[112:115], a[248:251], v[72:75]
    ds_read_b128 v[104:107], v10 offset:34816
    v_fma_f32 v187, v187, s65, s65
    v_mfma_f32_16x16x32_bf16 v[76:79], v[112:115], a[252:255], v[76:79]
    s_waitcnt lgkmcnt(5)
    v_rcp_f32 v187, v187
    v_mfma_f32_16x16x32_bf16 v[80:83], v[116:119], a[248:251], v[80:83]
    ds_read_b128 v[108:111], v10 offset:35840
    v_mul_f32 v36, v36, v186
    v_mfma_f32_16x16x32_bf16 v[84:87], v[116:119], a[252:255], v[84:87]
    s_waitcnt lgkmcnt(5)
    v_exp_f32 v185, -v53
    v_mfma_f32_16x16x32_bf16 v[64:67], v[120:123], v[128:131], v[64:67]
    ds_read_b128 v[112:115], v10 offset:36864
    v_mul_f32 v37, v37, v187
    v_mfma_f32_16x16x32_bf16 v[68:71], v[120:123], v[132:135], v[68:71]
    s_waitcnt lgkmcnt(5)
    v_exp_f32 v186, -v60
    v_mfma_f32_16x16x32_bf16 v[72:75], v[124:127], v[128:131], v[72:75]
    ds_read_b128 v[116:119], v10 offset:37888
    v_cvt_pk_bf16_f32 v180, v36, v37
    v_mfma_f32_16x16x32_bf16 v[76:79], v[124:127], v[132:135], v[76:79]
    s_waitcnt lgkmcnt(5)
    v_exp_f32 v187, -v61
    v_mfma_f32_16x16x32_bf16 v[80:83], v[96:99], v[128:131], v[80:83]
    ds_read_b128 v[120:123], v10 offset:38912
    v_mul_f32 v44, v44, v46
    v_mfma_f32_16x16x32_bf16 v[84:87], v[96:99], v[132:135], v[84:87]
    s_waitcnt lgkmcnt(5)
    v_mul_f32 v45, v45, v47
    v_fma_f32 v188, v188, s65, s65
    v_mfma_f32_16x16x32_bf16 v[64:67], v[100:103], v[136:139], v[64:67]
    ds_read_b128 v[124:127], v10 offset:39936
    v_fma_f32 v189, v189, s65, s65
    v_mfma_f32_16x16x32_bf16 v[68:71], v[100:103], v[140:143], v[68:71]
    s_waitcnt vmcnt(1) lgkmcnt(5)
    s_barrier
    v_rcp_f32 v188, v188
    v_mfma_f32_16x16x32_bf16 v[72:75], v[104:107], v[136:139], v[72:75]
    s_add_u32 m0, s47, 81920
    ds_read_b128 v[96:99], v10 offset:40960
    v_mul_f32 v44, v44, v188
    v_mfma_f32_16x16x32_bf16 v[76:79], v[104:107], v[140:143], v[76:79]
    s_waitcnt lgkmcnt(5)
    buffer_load_dwordx4 v243, s[4:7], m0 offen sc1 lds
    v_mfma_f32_16x16x32_bf16 v[80:83], v[108:111], v[136:139], v[80:83]
    s_add_u32 m0, s47, 86016
    ds_read_b128 v[100:103], v10 offset:41984
    v_mul_f32 v52, v52, v54
    v_mfma_f32_16x16x32_bf16 v[84:87], v[108:111], v[140:143], v[84:87]
    s_waitcnt lgkmcnt(5)
    v_rcp_f32 v189, v189
    v_mfma_f32_16x16x32_bf16 v[64:67], v[112:115], v[144:147], v[64:67]
    ds_read_b128 v[104:107], v10 offset:43008
    v_mul_f32 v45, v45, v189
    v_mfma_f32_16x16x32_bf16 v[68:71], v[112:115], v[148:151], v[68:71]
    s_waitcnt lgkmcnt(5)
    buffer_load_dwordx4 v243, s[4:7], m0 offen sc1 lds
    v_mfma_f32_16x16x32_bf16 v[72:75], v[116:119], v[144:147], v[72:75]
    s_add_u32 m0, s47, 90112
    ds_read_b128 v[108:111], v10 offset:44032
    v_cvt_pk_bf16_f32 v181, v44, v45
    v_mfma_f32_16x16x32_bf16 v[76:79], v[116:119], v[148:151], v[76:79]
    s_waitcnt lgkmcnt(5)
    v_mul_f32 v53, v53, v55
    v_fma_f32 v184, v184, s65, s65
    v_mfma_f32_16x16x32_bf16 v[80:83], v[120:123], v[144:147], v[80:83]
    ds_read_b128 v[112:115], v10 offset:45056
    v_fma_f32 v185, v185, s65, s65
    v_mfma_f32_16x16x32_bf16 v[84:87], v[120:123], v[148:151], v[84:87]
    s_waitcnt lgkmcnt(5)
    buffer_load_dwordx4 v243, s[4:7], m0 offen sc1 lds
    v_mfma_f32_16x16x32_bf16 v[64:67], v[124:127], v[152:155], v[64:67]
    s_add_u32 m0, s47, 94208
    ds_read_b128 v[116:119], v10 offset:46080
    v_mul_f32 v60, v60, v62
    v_mfma_f32_16x16x32_bf16 v[68:71], v[124:127], v[156:159], v[68:71]
    s_waitcnt lgkmcnt(5)
    v_rcp_f32 v184, v184
    v_mfma_f32_16x16x32_bf16 v[72:75], v[96:99], v[152:155], v[72:75]
    ds_read_b128 v[120:123], v10 offset:47104
    v_mul_f32 v52, v52, v184
    v_mfma_f32_16x16x32_bf16 v[76:79], v[96:99], v[156:159], v[76:79]
    s_waitcnt lgkmcnt(5)
    buffer_load_dwordx4 v243, s[4:7], m0 offen sc1 lds
    v_mfma_f32_16x16x32_bf16 v[80:83], v[100:103], v[152:155], v[80:83]
    ds_read_b128 v[124:127], v10 offset:48128
    v_mul_f32 v61, v61, v63
    v_mfma_f32_16x16x32_bf16 v[84:87], v[100:103], v[156:159], v[84:87]
    s_waitcnt lgkmcnt(5)
    v_rcp_f32 v185, v185
    v_mfma_f32_16x16x32_bf16 v[64:67], v[104:107], v[160:163], v[64:67]
    ds_read_b128 v[96:99], v11 offset:0
    v_mul_f32 v53, v53, v185
    v_mfma_f32_16x16x32_bf16 v[68:71], v[104:107], v[164:167], v[68:71]
    s_waitcnt lgkmcnt(5)
    v_cvt_pk_bf16_f32 v182, v52, v53
    v_fma_f32 v186, v186, s65, s65
    v_mfma_f32_16x16x32_bf16 v[72:75], v[108:111], v[160:163], v[72:75]
    ds_read_b128 v[100:103], v11 offset:1024
    v_fma_f32 v187, v187, s65, s65
    v_mfma_f32_16x16x32_bf16 v[76:79], v[108:111], v[164:167], v[76:79]
    s_waitcnt lgkmcnt(5)
    v_rcp_f32 v186, v186
    v_mfma_f32_16x16x32_bf16 v[80:83], v[112:115], v[160:163], v[80:83]
    ds_read_b128 v[104:107], v11 offset:2048
    v_mul_f32 v60, v60, v186
    v_mfma_f32_16x16x32_bf16 v[84:87], v[112:115], v[164:167], v[84:87]
    s_waitcnt lgkmcnt(5)
    v_rcp_f32 v187, v187
    v_mfma_f32_16x16x32_bf16 v[64:67], v[116:119], v[168:171], v[64:67]
    ds_read_b128 v[108:111], v11 offset:3072
    v_mul_f32 v61, v61, v187
    v_mfma_f32_16x16x32_bf16 v[68:71], v[116:119], v[172:175], v[68:71]
    s_waitcnt lgkmcnt(5)
    v_cvt_pk_bf16_f32 v183, v60, v61
    v_mfma_f32_16x16x32_bf16 v[72:75], v[120:123], v[168:171], v[72:75]
    ds_read_b128 v[112:115], v11 offset:4096
    v_mfma_f32_16x16x32_bf16 v[76:79], v[120:123], v[172:175], v[76:79]
    s_waitcnt lgkmcnt(5)
    buffer_store_dwordx4 v[180:183], v1, s[4:7], s46 offen offset:0 sc1
    v_mfma_f32_16x16x32_bf16 v[80:83], v[124:127], v[168:171], v[80:83]
    ds_read_b128 v[116:119], v11 offset:5120
    v_mfma_f32_16x16x32_bf16 v[84:87], v[124:127], v[172:175], v[84:87]
    s_waitcnt lgkmcnt(5)
    v_mfma_f32_16x16x32_bf16 v[32:35], v[96:99], a[176:179], 0
    ds_read_b128 v[120:123], v11 offset:6144
    v_mfma_f32_16x16x32_bf16 v[36:39], v[96:99], a[180:183], 0
    s_waitcnt lgkmcnt(5)
    buffer_load_dwordx2 v[246:247], v241, s[4:7], s77 offen sc1
    v_mfma_f32_16x16x32_bf16 v[40:43], v[100:103], a[176:179], 0
    ds_read_b128 v[124:127], v11 offset:7168
    v_mfma_f32_16x16x32_bf16 v[44:47], v[100:103], a[180:183], 0
    s_waitcnt lgkmcnt(5)
    v_mfma_f32_16x16x32_bf16 v[48:51], v[104:107], a[176:179], 0
    ds_read_b128 v[96:99], v11 offset:8192
    v_mfma_f32_16x16x32_bf16 v[52:55], v[104:107], a[180:183], 0
    s_waitcnt lgkmcnt(5)
    buffer_load_dwordx4 v[248:251], v1, s[4:7], s72 offen sc1
    v_mfma_f32_16x16x32_bf16 v[56:59], v[108:111], a[176:179], 0
    ds_read_b128 v[100:103], v11 offset:9216
    v_mfma_f32_16x16x32_bf16 v[60:63], v[108:111], a[180:183], 0
    s_waitcnt lgkmcnt(5)
    v_exp_f32 v184, -v64
    v_mfma_f32_16x16x32_bf16 v[32:35], v[112:115], a[184:187], v[32:35]
    ds_read_b128 v[104:107], v11 offset:10240
    v_mul_f32 v64, v64, v66
    v_mfma_f32_16x16x32_bf16 v[36:39], v[112:115], a[188:191], v[36:39]
    s_waitcnt lgkmcnt(5)
    buffer_load_dwordx4 v[252:255], v1, s[4:7], s72 offen offset:1024 sc1
    v_mfma_f32_16x16x32_bf16 v[40:43], v[116:119], a[184:187], v[40:43]
    ds_read_b128 v[108:111], v11 offset:11264
    v_fma_f32 v184, v184, s65, s65
    v_mfma_f32_16x16x32_bf16 v[44:47], v[116:119], a[188:191], v[44:47]
    s_waitcnt lgkmcnt(5)
    v_exp_f32 v185, -v65
    v_mfma_f32_16x16x32_bf16 v[48:51], v[120:123], a[184:187], v[48:51]
    ds_read_b128 v[112:115], v11 offset:12288
    v_mul_f32 v65, v65, v67
    v_mfma_f32_16x16x32_bf16 v[52:55], v[120:123], a[188:191], v[52:55]
    s_waitcnt lgkmcnt(5)
    v_rcp_f32 v184, v184
    v_mfma_f32_16x16x32_bf16 v[56:59], v[124:127], a[184:187], v[56:59]
    ds_read_b128 v[116:119], v11 offset:13312
    v_fma_f32 v185, v185, s65, s65
    v_mfma_f32_16x16x32_bf16 v[60:63], v[124:127], a[188:191], v[60:63]
    s_waitcnt lgkmcnt(5)
    v_rcp_f32 v185, v185
    v_mfma_f32_16x16x32_bf16 v[32:35], v[96:99], a[192:195], v[32:35]
    ds_read_b128 v[120:123], v11 offset:14336
    v_mul_f32 v64, v64, v184
    v_mfma_f32_16x16x32_bf16 v[36:39], v[96:99], a[196:199], v[36:39]
    s_waitcnt lgkmcnt(5)
    v_exp_f32 v186, -v72
    v_mfma_f32_16x16x32_bf16 v[40:43], v[100:103], a[192:195], v[40:43]
    ds_read_b128 v[124:127], v11 offset:15360
    v_mul_f32 v65, v65, v185
    v_mfma_f32_16x16x32_bf16 v[44:47], v[100:103], a[196:199], v[44:47]
    s_waitcnt lgkmcnt(5)
    v_exp_f32 v187, -v73
    v_mfma_f32_16x16x32_bf16 v[48:51], v[104:107], a[192:195], v[48:51]
    ds_read_b128 v[96:99], v11 offset:16384
    v_cvt_pk_bf16_f32 v176, v64, v65
    v_mfma_f32_16x16x32_bf16 v[52:55], v[104:107], a[196:199], v[52:55]
    s_waitcnt lgkmcnt(5)
    v_exp_f32 v188, -v80
    v_mfma_f32_16x16x32_bf16 v[56:59], v[108:111], a[192:195], v[56:59]
    ds_read_b128 v[100:103], v11 offset:17408
    v_mul_f32 v72, v72, v74
    v_mfma_f32_16x16x32_bf16 v[60:63], v[108:111], a[196:199], v[60:63]
    s_waitcnt lgkmcnt(5)
    v_exp_f32 v189, -v81
    v_mfma_f32_16x16x32_bf16 v[32:35], v[112:115], a[200:203], v[32:35]
    ds_read_b128 v[104:107], v11 offset:18432
    v_mul_f32 v73, v73, v75
    v_mfma_f32_16x16x32_bf16 v[36:39], v[112:115], a[204:207], v[36:39]
    s_waitcnt lgkmcnt(5)
    v_exp_f32 v184, -v68
    v_mfma_f32_16x16x32_bf16 v[40:43], v[116:119], a[200:203], v[40:43]
    ds_read_b128 v[108:111], v11 offset:19456
    v_fma_f32 v186, v186, s65, s65
    v_mfma_f32_16x16x32_bf16 v[44:47], v[116:119], a[204:207], v[44:47]
    s_waitcnt lgkmcnt(5)
    s_waitcnt vmcnt(3)
    s_mov_b64 exec, s[60:61]
    buffer_store_dword v30, off, s[4:7], s74 offset:4
    s_mov_b64 exec, s[62:63]
    buffer_store_dword v30, off, s[4:7], s74 offset:4 sc1
    s_mov_b64 exec, -1
    v_rcp_f32 v186, v186
    v_mfma_f32_16x16x32_bf16 v[48:51], v[120:123], a[200:203], v[48:51]
    ds_read_b128 v[112:115], v11 offset:20480
    v_fma_f32 v187, v187, s65, s65
    v_mfma_f32_16x16x32_bf16 v[52:55], v[120:123], a[204:207], v[52:55]
    s_waitcnt lgkmcnt(5)
    v_rcp_f32 v187, v187
    v_mfma_f32_16x16x32_bf16 v[56:59], v[124:127], a[200:203], v[56:59]
    ds_read_b128 v[116:119], v11 offset:21504
    v_mul_f32 v72, v72, v186
    v_mfma_f32_16x16x32_bf16 v[60:63], v[124:127], a[204:207], v[60:63]
    s_waitcnt lgkmcnt(5)
    v_exp_f32 v185, -v69
    v_mfma_f32_16x16x32_bf16 v[32:35], v[96:99], a[208:211], v[32:35]
    ds_read_b128 v[120:123], v11 offset:22528
    v_mul_f32 v73, v73, v187
    v_mfma_f32_16x16x32_bf16 v[36:39], v[96:99], a[212:215], v[36:39]
    s_waitcnt lgkmcnt(5)
    v_exp_f32 v186, -v76
    v_mfma_f32_16x16x32_bf16 v[40:43], v[100:103], a[208:211], v[40:43]
    ds_read_b128 v[124:127], v11 offset:23552
    v_cvt_pk_bf16_f32 v177, v72, v73
    v_mfma_f32_16x16x32_bf16 v[44:47], v[100:103], a[212:215], v[44:47]
    s_waitcnt lgkmcnt(5)
    v_exp_f32 v187, -v77
    v_mfma_f32_16x16x32_bf16 v[48:51], v[104:107], a[208:211], v[48:51]
    ds_read_b128 v[96:99], v11 offset:24576
    v_mul_f32 v80, v80, v82
    v_mfma_f32_16x16x32_bf16 v[52:55], v[104:107], a[212:215], v[52:55]
    s_waitcnt lgkmcnt(5)
    v_mul_f32 v81, v81, v83
    v_fma_f32 v188, v188, s65, s65
    v_mfma_f32_16x16x32_bf16 v[56:59], v[108:111], a[208:211], v[56:59]
    ds_read_b128 v[100:103], v11 offset:25600
    v_fma_f32 v189, v189, s65, s65
    v_mfma_f32_16x16x32_bf16 v[60:63], v[108:111], a[212:215], v[60:63]
    s_waitcnt lgkmcnt(5)
    v_rcp_f32 v188, v188
    v_mfma_f32_16x16x32_bf16 v[32:35], v[112:115], a[216:219], v[32:35]
    ds_read_b128 v[104:107], v11 offset:26624
    v_mul_f32 v80, v80, v188
    v_mfma_f32_16x16x32_bf16 v[36:39], v[112:115], a[220:223], v[36:39]
    s_waitcnt lgkmcnt(5)
    v_rcp_f32 v189, v189
    v_mfma_f32_16x16x32_bf16 v[40:43], v[116:119], a[216:219], v[40:43]
    ds_read_b128 v[108:111], v11 offset:27648
    v_mul_f32 v81, v81, v189
    v_mfma_f32_16x16x32_bf16 v[44:47], v[116:119], a[220:223], v[44:47]
    s_waitcnt lgkmcnt(5)
    v_exp_f32 v188, -v84
    v_mfma_f32_16x16x32_bf16 v[48:51], v[120:123], a[216:219], v[48:51]
    ds_read_b128 v[112:115], v11 offset:28672
    v_cvt_pk_bf16_f32 v178, v80, v81
    v_mfma_f32_16x16x32_bf16 v[52:55], v[120:123], a[220:223], v[52:55]
    s_waitcnt lgkmcnt(5)
    v_permlane32_swap_b32 v176, v178
    v_mfma_f32_16x16x32_bf16 v[56:59], v[124:127], a[216:219], v[56:59]
    ds_read_b128 v[116:119], v11 offset:29696
    v_mul_f32 v68, v68, v70
    v_mfma_f32_16x16x32_bf16 v[60:63], v[124:127], a[220:223], v[60:63]
    s_waitcnt lgkmcnt(5)
    v_permlane32_swap_b32 v177, v179
    v_mfma_f32_16x16x32_bf16 v[32:35], v[96:99], a[224:227], v[32:35]
    ds_read_b128 v[120:123], v11 offset:30720
    v_mul_f32 v69, v69, v71
    v_mfma_f32_16x16x32_bf16 v[36:39], v[96:99], a[228:231], v[36:39]
    s_waitcnt lgkmcnt(5)
    v_permlane16_swap_b32 v176, v177
    v_mfma_f32_16x16x32_bf16 v[40:43], v[100:103], a[224:227], v[40:43]
    ds_read_b128 v[124:127], v11 offset:31744
    v_fma_f32 v184, v184, s65, s65
    v_mfma_f32_16x16x32_bf16 v[44:47], v[100:103], a[228:231], v[44:47]
    s_waitcnt lgkmcnt(5)
    v_permlane16_swap_b32 v178, v179
    v_mfma_f32_16x16x32_bf16 v[48:51], v[104:107], a[224:227], v[48:51]
    ds_read_b128 v[96:99], v11 offset:32768
    v_fma_f32 v185, v185, s65, s65
    v_mfma_f32_16x16x32_bf16 v[52:55], v[104:107], a[228:231], v[52:55]
    s_waitcnt lgkmcnt(5)
    v_rcp_f32 v184, v184
    v_mfma_f32_16x16x32_bf16 v[56:59], v[108:111], a[224:227], v[56:59]
    ds_read_b128 v[100:103], v11 offset:33792
    v_mul_f32 v68, v68, v184
    v_mfma_f32_16x16x32_bf16 v[60:63], v[108:111], a[228:231], v[60:63]
    s_waitcnt lgkmcnt(5)
    v_rcp_f32 v185, v185
    v_mfma_f32_16x16x32_bf16 v[32:35], v[112:115], a[232:235], v[32:35]
    ds_read_b128 v[104:107], v11 offset:34816
    v_mul_f32 v69, v69, v185
    v_mfma_f32_16x16x32_bf16 v[36:39], v[112:115], a[236:239], v[36:39]
    s_waitcnt lgkmcnt(5)
    v_exp_f32 v189, -v85
    v_mfma_f32_16x16x32_bf16 v[40:43], v[116:119], a[232:235], v[40:43]
    ds_read_b128 v[108:111], v11 offset:35840
    v_cvt_pk_bf16_f32 v180, v68, v69
    v_mfma_f32_16x16x32_bf16 v[44:47], v[116:119], a[236:239], v[44:47]
    s_waitcnt lgkmcnt(5)
    v_mul_f32 v76, v76, v78
    v_mul_f32 v77, v77, v79
    v_mfma_f32_16x16x32_bf16 v[48:51], v[120:123], a[232:235], v[48:51]
    ds_read_b128 v[112:115], v11 offset:36864
    v_fma_f32 v186, v186, s65, s65
    v_mfma_f32_16x16x32_bf16 v[52:55], v[120:123], a[236:239], v[52:55]
    s_waitcnt lgkmcnt(5)
    v_rcp_f32 v186, v186
    v_mfma_f32_16x16x32_bf16 v[56:59], v[124:127], a[232:235], v[56:59]
    ds_read_b128 v[116:119], v11 offset:37888
    v_fma_f32 v187, v187, s65, s65
    v_mfma_f32_16x16x32_bf16 v[60:63], v[124:127], a[236:239], v[60:63]
    s_waitcnt lgkmcnt(5)
    buffer_load_dword v240, v239, s[4:7], s76 offen offset:4 sc1
    v_mfma_f32_16x16x32_bf16 v[32:35], v[96:99], a[240:243], v[32:35]
    ds_read_b128 v[120:123], v11 offset:38912
    v_mul_f32 v76, v76, v186
    v_mfma_f32_16x16x32_bf16 v[36:39], v[96:99], a[244:247], v[36:39]
    s_waitcnt lgkmcnt(5)
    v_rcp_f32 v187, v187
    v_mfma_f32_16x16x32_bf16 v[40:43], v[100:103], a[240:243], v[40:43]
    ds_read_b128 v[124:127], v11 offset:39936
    v_mul_f32 v77, v77, v187
    v_mfma_f32_16x16x32_bf16 v[44:47], v[100:103], a[244:247], v[44:47]
    s_waitcnt lgkmcnt(5)
    v_cvt_pk_bf16_f32 v181, v76, v77
    v_mul_f32 v84, v84, v86
    v_mfma_f32_16x16x32_bf16 v[48:51], v[104:107], a[240:243], v[48:51]
    ds_read_b128 v[96:99], v11 offset:40960
    v_mul_f32 v85, v85, v87
    v_mfma_f32_16x16x32_bf16 v[52:55], v[104:107], a[244:247], v[52:55]
    s_waitcnt lgkmcnt(5)
    v_fma_f32 v188, v188, s65, s65
    v_fma_f32 v189, v189, s65, s65
    v_mfma_f32_16x16x32_bf16 v[56:59], v[108:111], a[240:243], v[56:59]
    ds_read_b128 v[100:103], v11 offset:41984
    v_mfma_f32_16x16x32_bf16 v[60:63], v[108:111], a[244:247], v[60:63]
    s_waitcnt lgkmcnt(5)
    v_rcp_f32 v188, v188
    v_mfma_f32_16x16x32_bf16 v[32:35], v[112:115], a[248:251], v[32:35]
    ds_read_b128 v[104:107], v11 offset:43008
    v_mul_f32 v84, v84, v188
    v_mfma_f32_16x16x32_bf16 v[36:39], v[112:115], a[252:255], v[36:39]
    s_waitcnt lgkmcnt(5)
    v_rcp_f32 v189, v189
    v_mfma_f32_16x16x32_bf16 v[40:43], v[116:119], a[248:251], v[40:43]
    ds_read_b128 v[108:111], v11 offset:44032
    v_mul_f32 v85, v85, v189
    v_mfma_f32_16x16x32_bf16 v[44:47], v[116:119], a[252:255], v[44:47]
    s_waitcnt lgkmcnt(5)
    v_cvt_pk_bf16_f32 v182, v84, v85
    v_mfma_f32_16x16x32_bf16 v[48:51], v[120:123], a[248:251], v[48:51]
    ds_read_b128 v[112:115], v11 offset:45056
    v_mfma_f32_16x16x32_bf16 v[52:55], v[120:123], a[252:255], v[52:55]
    s_waitcnt lgkmcnt(5)
    v_permlane32_swap_b32 v180, v182
    v_mfma_f32_16x16x32_bf16 v[56:59], v[124:127], a[248:251], v[56:59]
    ds_read_b128 v[116:119], v11 offset:46080
    v_mfma_f32_16x16x32_bf16 v[60:63], v[124:127], a[252:255], v[60:63]
    s_waitcnt lgkmcnt(5)
    v_permlane32_swap_b32 v181, v183
    v_mfma_f32_16x16x32_bf16 v[32:35], v[96:99], v[128:131], v[32:35]
    ds_read_b128 v[120:123], v11 offset:47104
    v_mfma_f32_16x16x32_bf16 v[36:39], v[96:99], v[132:135], v[36:39]
    s_waitcnt lgkmcnt(5)
    v_permlane16_swap_b32 v180, v181
    v_mfma_f32_16x16x32_bf16 v[40:43], v[100:103], v[128:131], v[40:43]
    ds_read_b128 v[124:127], v11 offset:48128
    v_mfma_f32_16x16x32_bf16 v[44:47], v[100:103], v[132:135], v[44:47]
    s_waitcnt vmcnt(6) lgkmcnt(5)
    s_barrier
    v_permlane16_swap_b32 v182, v183
    v_mfma_f32_16x16x32_bf16 v[48:51], v[104:107], v[128:131], v[48:51]
    ds_read_b128 v[96:99], v10 offset:16384
    v_mfma_f32_16x16x32_bf16 v[52:55], v[104:107], v[132:135], v[52:55]
    s_waitcnt lgkmcnt(5)
    s_mov_b32 exec_hi, 0xffff
    buffer_store_dwordx4 v[176:179], v1, s[4:7], s78 offen offset:2048 sc1
    s_mov_b32 exec_hi, -1
    v_mfma_f32_16x16x32_bf16 v[56:59], v[108:111], v[128:131], v[56:59]
    ds_read_b128 v[100:103], v10 offset:17408
    v_mfma_f32_16x16x32_bf16 v[60:63], v[108:111], v[132:135], v[60:63]
    s_waitcnt lgkmcnt(5)
    v_mfma_f32_16x16x32_bf16 v[32:35], v[112:115], v[136:139], v[32:35]
    ds_read_b128 v[104:107], v10 offset:18432
    v_mfma_f32_16x16x32_bf16 v[36:39], v[112:115], v[140:143], v[36:39]
    s_waitcnt lgkmcnt(5)
    s_mov_b32 exec_hi, 0xffff
    buffer_store_dwordx4 v[180:183], v1, s[4:7], s46 offen offset:2048 sc1
    s_mov_b32 exec_hi, -1
    v_mfma_f32_16x16x32_bf16 v[40:43], v[116:119], v[136:139], v[40:43]
    ds_read_b128 v[108:111], v10 offset:19456
    v_mfma_f32_16x16x32_bf16 v[44:47], v[116:119], v[140:143], v[44:47]
    s_waitcnt lgkmcnt(5)
    v_mfma_f32_16x16x32_bf16 v[48:51], v[120:123], v[136:139], v[48:51]
    ds_read_b128 v[112:115], v10 offset:20480
    v_mfma_f32_16x16x32_bf16 v[52:55], v[120:123], v[140:143], v[52:55]
    s_waitcnt lgkmcnt(5)
    v_mfma_f32_16x16x32_bf16 v[56:59], v[124:127], v[136:139], v[56:59]
    ds_read_b128 v[116:119], v10 offset:21504
    v_mfma_f32_16x16x32_bf16 v[60:63], v[124:127], v[140:143], v[60:63]
    s_waitcnt lgkmcnt(5)
    s_waitcnt vmcnt(2)
    v_cmp_ne_u32 vcc, s28, v240
    s_cbranch_vccnz L_pA1_re
L_pA1_ok:
    buffer_load_dwordx4 v[192:195], v1, s[4:7], s96 offen offset:0 sc1
    v_mfma_f32_16x16x32_bf16 v[32:35], v[96:99], v[144:147], v[32:35]
    ds_read_b128 v[120:123], v10 offset:22528
    v_lshlrev_b32 v64, 16, v248
    v_mfma_f32_16x16x32_bf16 v[36:39], v[96:99], v[148:151], v[36:39]
    s_waitcnt lgkmcnt(5)
    v_and_b32 v65, 0xffff0000, v248
    v_fma_f32 v64, v64, v246, v247
    v_mfma_f32_16x16x32_bf16 v[40:43], v[100:103], v[144:147], v[40:43]
    ds_read_b128 v[124:127], v10 offset:23552
    v_fma_f32 v65, v65, v246, v247
    v_mfma_f32_16x16x32_bf16 v[44:47], v[100:103], v[148:151], v[44:47]
    s_waitcnt lgkmcnt(5)
    buffer_load_dwordx4 v[196:199], v1, s[4:7], s97 offen offset:0 sc1
    v_mfma_f32_16x16x32_bf16 v[48:51], v[104:107], v[144:147], v[48:51]
    ds_read_b128 v[96:99], v10 offset:24576
    v_lshlrev_b32 v66, 16, v249
    v_mfma_f32_16x16x32_bf16 v[52:55], v[104:107], v[148:151], v[52:55]
    s_waitcnt lgkmcnt(5)
    v_and_b32 v67, 0xffff0000, v249
    v_fma_f32 v66, v66, v246, v247
    v_mfma_f32_16x16x32_bf16 v[56:59], v[108:111], v[144:147], v[56:59]
    ds_read_b128 v[100:103], v10 offset:25600
    v_fma_f32 v67, v67, v246, v247
    v_mfma_f32_16x16x32_bf16 v[60:63], v[108:111], v[148:151], v[60:63]
    s_waitcnt lgkmcnt(5)
    buffer_load_dwordx4 v[200:203], v1, s[4:7], s98 offen offset:0 sc1
    v_mfma_f32_16x16x32_bf16 v[32:35], v[112:115], v[152:155], v[32:35]
    ds_read_b128 v[104:107], v10 offset:26624
    v_lshlrev_b32 v68, 16, v250
    v_mfma_f32_16x16x32_bf16 v[36:39], v[112:115], v[156:159], v[36:39]
    s_waitcnt lgkmcnt(5)
    v_and_b32 v69, 0xffff0000, v250
    v_fma_f32 v68, v68, v246, v247
    v_mfma_f32_16x16x32_bf16 v[40:43], v[116:119], v[152:155], v[40:43]
    ds_read_b128 v[108:111], v10 offset:27648
    v_fma_f32 v69, v69, v246, v247
    v_mfma_f32_16x16x32_bf16 v[44:47], v[116:119], v[156:159], v[44:47]
    s_waitcnt lgkmcnt(5)
    buffer_load_dwordx4 v[204:207], v1, s[4:7], s99 offen offset:0 sc1
    v_mfma_f32_16x16x32_bf16 v[48:51], v[120:123], v[152:155], v[48:51]
    s_add_u32 s96, s96, s84
    ds_read_b128 v[112:115], v10 offset:28672
    v_lshlrev_b32 v70, 16, v251
    v_mfma_f32_16x16x32_bf16 v[52:55], v[120:123], v[156:159], v[52:55]
    s_waitcnt lgkmcnt(5)
    v_and_b32 v71, 0xffff0000, v251
    v_fma_f32 v70, v70, v246, v247
    v_mfma_f32_16x16x32_bf16 v[56:59], v[124:127], v[152:155], v[56:59]
    ds_read_b128 v[116:119], v10 offset:29696
    v_fma_f32 v71, v71, v246, v247
    v_mfma_f32_16x16x32_bf16 v[60:63], v[124:127], v[156:159], v[60:63]
    s_waitcnt lgkmcnt(5)
    buffer_load_dwordx4 v[208:211], v1, s[4:7], s96 offen offset:0 sc1
    v_mfma_f32_16x16x32_bf16 v[32:35], v[96:99], v[160:163], v[32:35]
    s_add_u32 s97, s97, s84
    ds_read_b128 v[120:123], v10 offset:30720
    v_lshlrev_b32 v72, 16, v252
    v_mfma_f32_16x16x32_bf16 v[36:39], v[96:99], v[164:167], v[36:39]
    s_waitcnt lgkmcnt(5)
    v_and_b32 v73, 0xffff0000, v252
    v_fma_f32 v72, v72, v246, v247
    v_mfma_f32_16x16x32_bf16 v[40:43], v[100:103], v[160:163], v[40:43]
    ds_read_b128 v[124:127], v10 offset:31744
    v_fma_f32 v73, v73, v246, v247
    v_mfma_f32_16x16x32_bf16 v[44:47], v[100:103], v[164:167], v[44:47]
    s_waitcnt lgkmcnt(5)
    buffer_load_dwordx4 v[212:215], v1, s[4:7], s97 offen offset:0 sc1
    v_mfma_f32_16x16x32_bf16 v[48:51], v[104:107], v[160:163], v[48:51]
    s_add_u32 s98, s98, s84
    v_lshlrev_b32 v74, 16, v253
    v_mfma_f32_16x16x32_bf16 v[52:55], v[104:107], v[164:167], v[52:55]
    s_waitcnt lgkmcnt(4)
    v_and_b32 v75, 0xffff0000, v253
    v_fma_f32 v74, v74, v246, v247
    v_mfma_f32_16x16x32_bf16 v[56:59], v[108:111], v[160:163], v[56:59]
    v_fma_f32 v75, v75, v246, v247
    v_mfma_f32_16x16x32_bf16 v[60:63], v[108:111], v[164:167], v[60:63]
    s_waitcnt lgkmcnt(3)
    buffer_load_dwordx4 v[216:219], v1, s[4:7], s98 offen offset:0 sc1
    v_mfma_f32_16x16x32_bf16 v[32:35], v[112:115], v[168:171], v[32:35]
    v_lshlrev_b32 v76, 16, v254
    v_mfma_f32_16x16x32_bf16 v[36:39], v[112:115], v[172:175], v[36:39]
    s_waitcnt lgkmcnt(2)
    v_and_b32 v77, 0xffff0000, v254
    v_fma_f32 v76, v76, v246, v247
    v_mfma_f32_16x16x32_bf16 v[40:43], v[116:119], v[168:171], v[40:43]
    v_fma_f32 v77, v77, v246, v247
    v_mfma_f32_16x16x32_bf16 v[44:47], v[116:119], v[172:175], v[44:47]
    s_waitcnt lgkmcnt(1)
    v_lshlrev_b32 v78, 16, v255
    v_and_b32 v79, 0xffff0000, v255
    v_mfma_f32_16x16x32_bf16 v[48:51], v[120:123], v[168:171], v[48:51]
    v_fma_f32 v78, v78, v246, v247
    v_mfma_f32_16x16x32_bf16 v[52:55], v[120:123], v[172:175], v[52:55]
    s_waitcnt lgkmcnt(0)
    v_fma_f32 v79, v79, v246, v247
    v_mfma_f32_16x16x32_bf16 v[56:59], v[124:127], v[168:171], v[56:59]
    v_mfma_f32_16x16x32_bf16 v[60:63], v[124:127], v[172:175], v[60:63]
    v_exp_f32 v184, -v32
    v_exp_f32 v185, -v33
    v_exp_f32 v186, -v40
    v_pk_mul_f32 v[32:33], v[32:33], v[34:35]
    v_exp_f32 v187, -v41
    v_pk_fma_f32 v[184:185], v[184:185], s[30:31], s[30:31]
    v_rcp_f32 v184, v184
    v_pk_mul_f32 v[40:41], v[40:41], v[42:43]
    v_rcp_f32 v185, v185
    v_pk_fma_f32 v[186:187], v[186:187], s[30:31], s[30:31]
    v_rcp_f32 v186, v186
    v_pk_mul_f32 v[32:33], v[32:33], v[184:185]
    v_rcp_f32 v187, v187
    v_cvt_pk_bf16_f32 v176, v32, v33
    v_exp_f32 v188, -v48
    v_pk_mul_f32 v[40:41], v[40:41], v[186:187]
    v_exp_f32 v189, -v49
    v_cvt_pk_bf16_f32 v177, v40, v41
    v_exp_f32 v184, -v56
    v_pk_mul_f32 v[48:49], v[48:49], v[50:51]
    v_exp_f32 v185, -v57
    v_pk_fma_f32 v[188:189], v[188:189], s[30:31], s[30:31]
    v_rcp_f32 v188, v188
    v_pk_mul_f32 v[56:57], v[56:57], v[58:59]
    v_rcp_f32 v189, v189
    v_pk_fma_f32 v[184:185], v[184:185], s[30:31], s[30:31]
    v_rcp_f32 v184, v184
    v_pk_mul_f32 v[48:49], v[48:49], v[188:189]
    s_waitcnt vmcnt(7)
    s_mov_b64 exec, s[60:61]
    buffer_store_dword v30, off, s[4:7], s74 offset:8
    s_mov_b64 exec, s[62:63]
    buffer_store_dword v30, off, s[4:7], s74 offset:8 sc1
    s_mov_b64 exec, -1
    v_rcp_f32 v185, v185
    v_cvt_pk_bf16_f32 v178, v48, v49
    s_add_u32 s99, s99, s84
    buffer_load_dwordx4 v[220:223], v1, s[4:7], s99 offen offset:0 sc1
    v_exp_f32 v186, -v36
    v_pk_mul_f32 v[56:57], v[56:57], v[184:185]
    v_exp_f32 v187, -v37
    v_cvt_pk_bf16_f32 v179, v56, v57
    v_exp_f32 v188, -v44
    v_pk_mul_f32 v[36:37], v[36:37], v[38:39]
    v_exp_f32 v189, -v45
    v_pk_fma_f32 v[186:187], v[186:187], s[30:31], s[30:31]
    v_rcp_f32 v186, v186
    v_pk_mul_f32 v[44:45], v[44:45], v[46:47]
    s_add_u32 s96, s96, s85
    buffer_load_dwordx4 v[224:227], v1, s[4:7], s96 offen offset:0 sc1
    v_rcp_f32 v187, v187
    v_pk_fma_f32 v[188:189], v[188:189], s[30:31], s[30:31]
    v_rcp_f32 v188, v188
    v_pk_mul_f32 v[36:37], v[36:37], v[186:187]
    v_rcp_f32 v189, v189
    v_cvt_pk_bf16_f32 v180, v36, v37
    v_exp_f32 v184, -v52
    v_pk_mul_f32 v[44:45], v[44:45], v[188:189]
    v_exp_f32 v185, -v53
    v_cvt_pk_bf16_f32 v181, v44, v45
    s_add_u32 s97, s97, s85
    buffer_load_dwordx4 v[228:231], v1, s[4:7], s97 offen offset:0 sc1
    v_exp_f32 v186, -v60
    v_pk_mul_f32 v[52:53], v[52:53], v[54:55]
    v_exp_f32 v187, -v61
    v_pk_fma_f32 v[184:185], v[184:185], s[30:31], s[30:31]
    v_rcp_f32 v184, v184
    v_pk_mul_f32 v[60:61], v[60:61], v[62:63]
    v_rcp_f32 v185, v185
    v_pk_fma_f32 v[186:187], v[186:187], s[30:31], s[30:31]
    v_rcp_f32 v186, v186
    v_pk_mul_f32 v[52:53], v[52:53], v[184:185]
    s_add_u32 s98, s98, s85
    buffer_load_dwordx4 v[232:235], v1, s[4:7], s98 offen offset:0 sc1
    v_rcp_f32 v187, v187
    v_cvt_pk_bf16_f32 v182, v52, v53
    v_pk_mul_f32 v[60:61], v[60:61], v[186:187]
    v_cvt_pk_bf16_f32 v183, v60, v61
    buffer_load_dword v240, v239, s[4:7], s76 offen offset:8 sc1
    buffer_store_dwordx4 v[176:179], v1, s[4:7], s78 offen offset:1024 sc1
    buffer_store_dwordx4 v[180:183], v1, s[4:7], s46 offen offset:1024 sc1
    s_add_u32 s99, s99, s85
    buffer_load_dwordx4 v[160:163], v1, s[4:7], s99 offen offset:0 sc1
    s_waitcnt vmcnt(15)
    v_mfma_f32_16x16x32_bf16 v[32:35], a[0:3], v[192:195], 0
    s_add_u32 s96, s96, s86
    buffer_load_dwordx4 v[164:167], v1, s[4:7], s96 offen offset:0 sc1
    v_mfma_f32_16x16x32_bf16 v[36:39], a[4:7], v[192:195], 0
    s_add_u32 s97, s97, s86
    v_mfma_f32_16x16x32_bf16 v[40:43], a[8:11], v[192:195], 0
    v_mfma_f32_16x16x32_bf16 v[44:47], a[12:15], v[192:195], 0
    s_waitcnt vmcnt(15)
    v_mfma_f32_16x16x32_bf16 v[48:51], a[0:3], v[196:199], 0
    buffer_load_dwordx4 v[168:171], v1, s[4:7], s97 offen offset:0 sc1
    v_mfma_f32_16x16x32_bf16 v[52:55], a[4:7], v[196:199], 0
    s_add_u32 s98, s98, s86
    v_mfma_f32_16x16x32_bf16 v[56:59], a[8:11], v[196:199], 0
    v_mfma_f32_16x16x32_bf16 v[60:63], a[12:15], v[196:199], 0
    s_waitcnt vmcnt(15)
    v_mfma_f32_16x16x32_bf16 v[80:83], a[0:3], v[200:203], 0
    buffer_load_dwordx4 v[172:175], v1, s[4:7], s98 offen offset:0 sc1
    v_mfma_f32_16x16x32_bf16 v[84:87], a[4:7], v[200:203], 0
    s_add_u32 s99, s99, s86
    v_mfma_f32_16x16x32_bf16 v[88:91], a[8:11], v[200:203], 0
    v_mfma_f32_16x16x32_bf16 v[92:95], a[12:15], v[200:203], 0
    s_waitcnt vmcnt(15)
    v_mfma_f32_16x16x32_bf16 v[64:67], a[0:3], v[204:207], v[64:67]
    buffer_load_dwordx4 v[96:99], v1, s[4:7], s99 offen offset:0 sc1
    v_mfma_f32_16x16x32_bf16 v[68:71], a[4:7], v[204:207], v[68:71]
    s_sub_u32 s96, s96, s87
    v_mfma_f32_16x16x32_bf16 v[72:75], a[8:11], v[204:207], v[72:75]
    v_mfma_f32_16x16x32_bf16 v[76:79], a[12:15], v[204:207], v[76:79]
    s_waitcnt vmcnt(15)
    v_mfma_f32_16x16x32_bf16 v[32:35], a[32:35], v[208:211], v[32:35]
    v_mfma_f32_16x16x32_bf16 v[36:39], a[36:39], v[208:211], v[36:39]
    v_mfma_f32_16x16x32_bf16 v[40:43], a[40:43], v[208:211], v[40:43]
    v_mfma_f32_16x16x32_bf16 v[44:47], a[44:47], v[208:211], v[44:47]
    s_waitcnt vmcnt(14)
    v_mfma_f32_16x16x32_bf16 v[48:51], a[32:35], v[212:215], v[48:51]
    v_mfma_f32_16x16x32_bf16 v[52:55], a[36:39], v[212:215], v[52:55]
    v_mfma_f32_16x16x32_bf16 v[56:59], a[40:43], v[212:215], v[56:59]
    v_mfma_f32_16x16x32_bf16 v[60:63], a[44:47], v[212:215], v[60:63]
    s_waitcnt vmcnt(13)
    v_mfma_f32_16x16x32_bf16 v[80:83], a[32:35], v[216:219], v[80:83]
    v_mfma_f32_16x16x32_bf16 v[84:87], a[36:39], v[216:219], v[84:87]
    v_mfma_f32_16x16x32_bf16 v[88:91], a[40:43], v[216:219], v[88:91]
    v_mfma_f32_16x16x32_bf16 v[92:95], a[44:47], v[216:219], v[92:95]
    s_waitcnt vmcnt(11)
    v_mfma_f32_16x16x32_bf16 v[64:67], a[32:35], v[220:223], v[64:67]
    v_mfma_f32_16x16x32_bf16 v[68:71], a[36:39], v[220:223], v[68:71]
    v_mfma_f32_16x16x32_bf16 v[72:75], a[40:43], v[220:223], v[72:75]
    v_mfma_f32_16x16x32_bf16 v[76:79], a[44:47], v[220:223], v[76:79]
    s_waitcnt vmcnt(10)
    v_mfma_f32_16x16x32_bf16 v[32:35], a[64:67], v[224:227], v[32:35]
    v_mfma_f32_16x16x32_bf16 v[36:39], a[68:71], v[224:227], v[36:39]
    v_mfma_f32_16x16x32_bf16 v[40:43], a[72:75], v[224:227], v[40:43]
    v_mfma_f32_16x16x32_bf16 v[44:47], a[76:79], v[224:227], v[44:47]
    s_waitcnt vmcnt(9)
    v_mfma_f32_16x16x32_bf16 v[48:51], a[64:67], v[228:231], v[48:51]
    v_mfma_f32_16x16x32_bf16 v[52:55], a[68:71], v[228:231], v[52:55]
    v_mfma_f32_16x16x32_bf16 v[56:59], a[72:75], v[228:231], v[56:59]
    v_mfma_f32_16x16x32_bf16 v[60:63], a[76:79], v[228:231], v[60:63]
    s_waitcnt vmcnt(8)
    v_mfma_f32_16x16x32_bf16 v[80:83], a[64:67], v[232:235], v[80:83]
    s_waitcnt vmcnt(7)
    v_cmp_ne_u32 vcc, s28, v240
    s_cbranch_vccnz L_pR1_re
L_pR1_ok:
    buffer_load_dwordx4 a[176:179], v24, s[4:7], s96 offen offset:2048 sc1
    s_sub_u32 s97, s97, s87
    buffer_load_dwordx4 a[180:183], v24, s[4:7], s97 offen offset:2048 sc1
    s_sub_u32 s98, s98, s87
    buffer_load_dwordx4 a[184:187], v24, s[4:7], s98 offen offset:2048 sc1
    v_mfma_f32_16x16x32_bf16 v[84:87], a[68:71], v[232:235], v[84:87]
    s_sub_u32 s99, s99, s87
    v_mfma_f32_16x16x32_bf16 v[88:91], a[72:75], v[232:235], v[88:91]
    v_mfma_f32_16x16x32_bf16 v[92:95], a[76:79], v[232:235], v[92:95]
    s_waitcnt vmcnt(8)
    s_mov_b64 exec, s[60:61]
    buffer_store_dword v30, off, s[4:7], s74 offset:12
    s_mov_b64 exec, s[62:63]
    buffer_store_dword v30, off, s[4:7], s74 offset:12 sc1
    s_mov_b64 exec, -1
    s_waitcnt vmcnt(8)
    v_mfma_f32_16x16x32_bf16 v[64:67], a[64:67], v[160:163], v[64:67]
    buffer_load_dwordx4 a[188:191], v24, s[4:7], s99 offen offset:2048 sc1
    v_mfma_f32_16x16x32_bf16 v[68:71], a[68:71], v[160:163], v[68:71]
    v_mfma_f32_16x16x32_bf16 v[72:75], a[72:75], v[160:163], v[72:75]
    v_mfma_f32_16x16x32_bf16 v[76:79], a[76:79], v[160:163], v[76:79]
    s_waitcnt vmcnt(8)
    v_mfma_f32_16x16x32_bf16 v[32:35], a[96:99], v[164:167], v[32:35]
    buffer_load_dwordx4 a[192:195], v25, s[4:7], s96 offen offset:2048 sc1
    v_mfma_f32_16x16x32_bf16 v[36:39], a[100:103], v[164:167], v[36:39]
    v_mfma_f32_16x16x32_bf16 v[40:43], a[104:107], v[164:167], v[40:43]
    v_mfma_f32_16x16x32_bf16 v[44:47], a[108:111], v[164:167], v[44:47]
    s_waitcnt vmcnt(8)
    v_mfma_f32_16x16x32_bf16 v[48:51], a[96:99], v[168:171], v[48:51]
    buffer_load_dwordx4 a[196:199], v25, s[4:7], s97 offen offset:2048 sc1
    v_mfma_f32_16x16x32_bf16 v[52:55], a[100:103], v[168:171], v[52:55]
    v_mfma_f32_16x16x32_bf16 v[56:59], a[104:107], v[168:171], v[56:59]
    v_mfma_f32_16x16x32_bf16 v[60:63], a[108:111], v[168:171], v[60:63]
    s_waitcnt vmcnt(8)
    v_mfma_f32_16x16x32_bf16 v[80:83], a[96:99], v[172:175], v[80:83]
    buffer_load_dwordx4 a[200:203], v25, s[4:7], s98 offen offset:2048 sc1
    v_mfma_f32_16x16x32_bf16 v[84:87], a[100:103], v[172:175], v[84:87]
    v_mfma_f32_16x16x32_bf16 v[88:91], a[104:107], v[172:175], v[88:91]
    v_mfma_f32_16x16x32_bf16 v[92:95], a[108:111], v[172:175], v[92:95]
    s_waitcnt vmcnt(8)
    v_mfma_f32_16x16x32_bf16 v[64:67], a[96:99], v[96:99], v[64:67]
    buffer_load_dwordx4 a[204:207], v25, s[4:7], s99 offen offset:2048 sc1
    v_mfma_f32_16x16x32_bf16 v[68:71], a[100:103], v[96:99], v[68:71]
    v_mfma_f32_16x16x32_bf16 v[72:75], a[104:107], v[96:99], v[72:75]
    v_mfma_f32_16x16x32_bf16 v[76:79], a[108:111], v[96:99], v[76:79]
    s_waitcnt vmcnt(8)
    v_mfma_f32_16x16x32_bf16 v[32:35], a[128:131], a[176:179], v[32:35]
    buffer_load_dwordx4 a[208:211], v26, s[4:7], s96 offen offset:2048 sc1
    v_mfma_f32_16x16x32_bf16 v[36:39], a[132:135], a[176:179], v[36:39]
    v_mfma_f32_16x16x32_bf16 v[40:43], a[136:139], a[176:179], v[40:43]
    v_mfma_f32_16x16x32_bf16 v[44:47], a[140:143], a[176:179], v[44:47]
    s_waitcnt vmcnt(8)
    v_mfma_f32_16x16x32_bf16 v[48:51], a[128:131], a[180:183], v[48:51]
    buffer_load_dwordx4 a[212:215], v26, s[4:7], s97 offen offset:2048 sc1
    v_mfma_f32_16x16x32_bf16 v[52:55], a[132:135], a[180:183], v[52:55]
    v_mfma_f32_16x16x32_bf16 v[56:59], a[136:139], a[180:183], v[56:59]
    buffer_load_dword v240, v239, s[4:7], s76 offen offset:12 sc1
    v_mfma_f32_16x16x32_bf16 v[60:63], a[140:143], a[180:183], v[60:63]
    s_waitcnt vmcnt(9)
    v_mfma_f32_16x16x32_bf16 v[80:83], a[128:131], a[184:187], v[80:83]
    buffer_load_dwordx4 a[216:219], v26, s[4:7], s98 offen offset:2048 sc1
    v_mfma_f32_16x16x32_bf16 v[84:87], a[132:135], a[184:187], v[84:87]
    v_mfma_f32_16x16x32_bf16 v[88:91], a[136:139], a[184:187], v[88:91]
    v_mfma_f32_16x16x32_bf16 v[92:95], a[140:143], a[184:187], v[92:95]
    s_waitcnt vmcnt(8)
    v_mfma_f32_16x16x32_bf16 v[64:67], a[128:131], a[188:191], v[64:67]
    buffer_load_dwordx4 a[220:223], v26, s[4:7], s99 offen offset:2048 sc1
    v_mfma_f32_16x16x32_bf16 v[68:71], a[132:135], a[188:191], v[68:71]
    s_add_u32 s96, s96, s88
    v_mfma_f32_16x16x32_bf16 v[72:75], a[136:139], a[188:191], v[72:75]
    v_mfma_f32_16x16x32_bf16 v[76:79], a[140:143], a[188:191], v[76:79]
    s_waitcnt vmcnt(8)
    v_mfma_f32_16x16x32_bf16 v[32:35], a[144:147], a[192:195], v[32:35]
    v_mfma_f32_16x16x32_bf16 v[36:39], a[148:151], a[192:195], v[36:39]
    v_mfma_f32_16x16x32_bf16 v[40:43], a[152:155], a[192:195], v[40:43]
    v_mfma_f32_16x16x32_bf16 v[44:47], a[156:159], a[192:195], v[44:47]
    s_waitcnt vmcnt(7)
    v_mfma_f32_16x16x32_bf16 v[48:51], a[144:147], a[196:199], v[48:51]
    v_mfma_f32_16x16x32_bf16 v[52:55], a[148:151], a[196:199], v[52:55]
    v_mfma_f32_16x16x32_bf16 v[56:59], a[152:155], a[196:199], v[56:59]
    v_mfma_f32_16x16x32_bf16 v[60:63], a[156:159], a[196:199], v[60:63]
    s_waitcnt vmcnt(6)
    v_mfma_f32_16x16x32_bf16 v[80:83], a[144:147], a[200:203], v[80:83]
    v_mfma_f32_16x16x32_bf16 v[84:87], a[148:151], a[200:203], v[84:87]
    v_mfma_f32_16x16x32_bf16 v[88:91], a[152:155], a[200:203], v[88:91]
    v_mfma_f32_16x16x32_bf16 v[92:95], a[156:159], a[200:203], v[92:95]
    s_waitcnt vmcnt(5)
    v_mfma_f32_16x16x32_bf16 v[64:67], a[144:147], a[204:207], v[64:67]
    v_mfma_f32_16x16x32_bf16 v[68:71], a[148:151], a[204:207], v[68:71]
    v_mfma_f32_16x16x32_bf16 v[72:75], a[152:155], a[204:207], v[72:75]
    v_mfma_f32_16x16x32_bf16 v[76:79], a[156:159], a[204:207], v[76:79]
    s_waitcnt vmcnt(4)
    v_mfma_f32_16x16x32_bf16 v[32:35], a[160:163], a[208:211], v[32:35]
    s_waitcnt vmcnt(2)
    v_cmp_ne_u32 vcc, s28, v240
    s_cbranch_vccnz L_pB1_re
L_pB1_ok:
    buffer_load_dwordx4 a[224:227], v1, s[4:7], s96 offen offset:1024 sc1
    s_add_u32 s96, s96, s84
    buffer_load_dwordx4 a[228:231], v1, s[4:7], s96 offen offset:1024 sc1
    s_add_u32 s96, s96, s85
    buffer_load_dwordx4 a[232:235], v1, s[4:7], s96 offen offset:1024 sc1
    s_add_u32 s96, s96, s86
    buffer_load_dwordx4 a[236:239], v1, s[4:7], s96 offen offset:1024 sc1
    s_add_u32 s97, s97, s88
    buffer_load_dwordx4 a[240:243], v1, s[4:7], s97 offen offset:1024 sc1
    s_add_u32 s97, s97, s84
    buffer_load_dwordx4 a[244:247], v1, s[4:7], s97 offen offset:1024 sc1
    s_add_u32 s97, s97, s85
    buffer_load_dwordx4 a[248:251], v1, s[4:7], s97 offen offset:1024 sc1
    s_add_u32 s97, s97, s86
    buffer_load_dwordx4 a[252:255], v1, s[4:7], s97 offen offset:1024 sc1
    s_add_u32 s98, s98, s88
    buffer_load_dwordx4 v[128:131], v1, s[4:7], s98 offen offset:1024 sc1
    s_add_u32 s98, s98, s84
    buffer_load_dwordx4 v[132:135], v1, s[4:7], s98 offen offset:1024 sc1
    v_mfma_f32_16x16x32_bf16 v[36:39], a[164:167], a[208:211], v[36:39]
    s_add_u32 s98, s98, s85
    v_mfma_f32_16x16x32_bf16 v[40:43], a[168:171], a[208:211], v[40:43]
    v_mfma_f32_16x16x32_bf16 v[44:47], a[172:175], a[208:211], v[44:47]
    s_waitcnt vmcnt(13)
    v_mfma_f32_16x16x32_bf16 v[48:51], a[160:163], a[212:215], v[48:51]
    buffer_load_dwordx4 v[136:139], v1, s[4:7], s98 offen offset:1024 sc1
    v_mfma_f32_16x16x32_bf16 v[52:55], a[164:167], a[212:215], v[52:55]
    s_add_u32 s98, s98, s86
    v_mfma_f32_16x16x32_bf16 v[56:59], a[168:171], a[212:215], v[56:59]
    v_mfma_f32_16x16x32_bf16 v[60:63], a[172:175], a[212:215], v[60:63]
    s_waitcnt vmcnt(12)
    v_mfma_f32_16x16x32_bf16 v[80:83], a[160:163], a[216:219], v[80:83]
    buffer_load_dwordx4 v[140:143], v1, s[4:7], s98 offen offset:1024 sc1
    v_mfma_f32_16x16x32_bf16 v[84:87], a[164:167], a[216:219], v[84:87]
    s_add_u32 s99, s99, s88
    v_mfma_f32_16x16x32_bf16 v[88:91], a[168:171], a[216:219], v[88:91]
    v_mfma_f32_16x16x32_bf16 v[92:95], a[172:175], a[216:219], v[92:95]
    s_waitcnt vmcnt(12)
    v_mfma_f32_16x16x32_bf16 v[64:67], a[160:163], a[220:223], v[64:67]
    buffer_load_dwordx4 v[144:147], v1, s[4:7], s99 offen offset:1024 sc1
    v_mfma_f32_16x16x32_bf16 v[68:71], a[164:167], a[220:223], v[68:71]
    s_add_u32 s99, s99, s84
    v_mfma_f32_16x16x32_bf16 v[72:75], a[168:171], a[220:223], v[72:75]
    v_mfma_f32_16x16x32_bf16 v[76:79], a[172:175], a[220:223], v[76:79]
    s_waitcnt vmcnt(12)
    v_mfma_f32_16x16x32_bf16 v[32:35], a[16:19], a[224:227], v[32:35]
    buffer_load_dwordx4 v[148:151], v1, s[4:7], s99 offen offset:1024 sc1
    v_mfma_f32_16x16x32_bf16 v[36:39], a[20:23], a[224:227], v[36:39]
    s_add_u32 s99, s99, s85
    v_mfma_f32_16x16x32_bf16 v[40:43], a[24:27], a[224:227], v[40:43]
    v_mfma_f32_16x16x32_bf16 v[44:47], a[28:31], a[224:227], v[44:47]
    s_waitcnt vmcnt(12)
    v_mfma_f32_16x16x32_bf16 v[32:35], a[48:51], a[228:231], v[32:35]
    buffer_load_dwordx4 v[152:155], v1, s[4:7], s99 offen offset:1024 sc1
    v_mfma_f32_16x16x32_bf16 v[36:39], a[52:55], a[228:231], v[36:39]
    s_add_u32 s99, s99, s86
    v_mfma_f32_16x16x32_bf16 v[40:43], a[56:59], a[228:231], v[40:43]
    v_mfma_f32_16x16x32_bf16 v[44:47], a[60:63], a[228:231], v[44:47]
    s_waitcnt vmcnt(12)
    v_mfma_f32_16x16x32_bf16 v[32:35], a[80:83], a[232:235], v[32:35]
    buffer_load_dwordx4 v[156:159], v1, s[4:7], s99 offen offset:1024 sc1
    v_mfma_f32_16x16x32_bf16 v[36:39], a[84:87], a[232:235], v[36:39]
    v_mfma_f32_16x16x32_bf16 v[40:43], a[88:91], a[232:235], v[40:43]
    v_mfma_f32_16x16x32_bf16 v[44:47], a[92:95], a[232:235], v[44:47]
    s_waitcnt vmcnt(12)
    v_mfma_f32_16x16x32_bf16 v[32:35], a[112:115], a[236:239], v[32:35]
    v_mfma_f32_16x16x32_bf16 v[36:39], a[116:119], a[236:239], v[36:39]
    v_mfma_f32_16x16x32_bf16 v[40:43], a[120:123], a[236:239], v[40:43]
    v_mfma_f32_16x16x32_bf16 v[44:47], a[124:127], a[236:239], v[44:47]
    s_waitcnt vmcnt(11)
    v_mfma_f32_16x16x32_bf16 v[48:51], a[16:19], a[240:243], v[48:51]
    v_mfma_f32_16x16x32_bf16 v[52:55], a[20:23], a[240:243], v[52:55]
    v_mfma_f32_16x16x32_bf16 v[56:59], a[24:27], a[240:243], v[56:59]
    v_mfma_f32_16x16x32_bf16 v[60:63], a[28:31], a[240:243], v[60:63]
    ds_write_b128 v12, v[32:35] offset:0
    s_waitcnt vmcnt(10)
    v_mfma_f32_16x16x32_bf16 v[48:51], a[48:51], a[244:247], v[48:51]
    v_mfma_f32_16x16x32_bf16 v[52:55], a[52:55], a[244:247], v[52:55]
    ds_write_b128 v12, v[36:39] offset:1024
    v_mfma_f32_16x16x32_bf16 v[56:59], a[56:59], a[244:247], v[56:59]
    v_mfma_f32_16x16x32_bf16 v[60:63], a[60:63], a[244:247], v[60:63]
    s_waitcnt vmcnt(9)
    v_mfma_f32_16x16x32_bf16 v[48:51], a[80:83], a[248:251], v[48:51]
    v_mfma_f32_16x16x32_bf16 v[52:55], a[84:87], a[248:251], v[52:55]
    ds_write_b128 v12, v[40:43] offset:2048
    v_mfma_f32_16x16x32_bf16 v[56:59], a[88:91], a[248:251], v[56:59]
    v_mfma_f32_16x16x32_bf16 v[60:63], a[92:95], a[248:251], v[60:63]
    s_waitcnt vmcnt(8)
    v_mfma_f32_16x16x32_bf16 v[48:51], a[112:115], a[252:255], v[48:51]
    v_mfma_f32_16x16x32_bf16 v[52:55], a[116:119], a[252:255], v[52:55]
    ds_write_b128 v12, v[44:47] offset:3072
    v_mfma_f32_16x16x32_bf16 v[56:59], a[120:123], a[252:255], v[56:59]
    v_mfma_f32_16x16x32_bf16 v[60:63], a[124:127], a[252:255], v[60:63]
    s_waitcnt vmcnt(7)
    v_mfma_f32_16x16x32_bf16 v[80:83], a[16:19], v[128:131], v[80:83]
    v_mfma_f32_16x16x32_bf16 v[84:87], a[20:23], v[128:131], v[84:87]
    v_mfma_f32_16x16x32_bf16 v[88:91], a[24:27], v[128:131], v[88:91]
    v_mfma_f32_16x16x32_bf16 v[92:95], a[28:31], v[128:131], v[92:95]
    ds_write_b128 v13, v[48:51] offset:0
    s_waitcnt vmcnt(6)
    v_mfma_f32_16x16x32_bf16 v[80:83], a[48:51], v[132:135], v[80:83]
    v_mfma_f32_16x16x32_bf16 v[84:87], a[52:55], v[132:135], v[84:87]
    ds_write_b128 v13, v[52:55] offset:1024
    v_mfma_f32_16x16x32_bf16 v[88:91], a[56:59], v[132:135], v[88:91]
    v_mfma_f32_16x16x32_bf16 v[92:95], a[60:63], v[132:135], v[92:95]
    s_waitcnt vmcnt(5)
    v_mfma_f32_16x16x32_bf16 v[80:83], a[80:83], v[136:139], v[80:83]
    v_mfma_f32_16x16x32_bf16 v[84:87], a[84:87], v[136:139], v[84:87]
    ds_write_b128 v13, v[56:59] offset:2048
    v_mfma_f32_16x16x32_bf16 v[88:91], a[88:91], v[136:139], v[88:91]
    v_mfma_f32_16x16x32_bf16 v[92:95], a[92:95], v[136:139], v[92:95]
    s_waitcnt vmcnt(4)
    v_mfma_f32_16x16x32_bf16 v[80:83], a[112:115], v[140:143], v[80:83]
    v_mfma_f32_16x16x32_bf16 v[84:87], a[116:119], v[140:143], v[84:87]
    ds_write_b128 v13, v[60:63] offset:3072
    v_mfma_f32_16x16x32_bf16 v[88:91], a[120:123], v[140:143], v[88:91]
    v_mfma_f32_16x16x32_bf16 v[92:95], a[124:127], v[140:143], v[92:95]
    s_waitcnt vmcnt(3)
    v_mfma_f32_16x16x32_bf16 v[64:67], a[16:19], v[144:147], v[64:67]
    s_waitcnt lgkmcnt(0)
    s_barrier
    ds_read_b128 v[100:103], v15 offset:0
    v_mfma_f32_16x16x32_bf16 v[68:71], a[20:23], v[144:147], v[68:71]
    v_mfma_f32_16x16x32_bf16 v[72:75], a[24:27], v[144:147], v[72:75]
    ds_read_b128 v[116:119], v15 offset:4096
    ds_read_b128 v[104:107], v15 offset:1024
    v_mfma_f32_16x16x32_bf16 v[76:79], a[28:31], v[144:147], v[76:79]
    ds_read_b128 v[120:123], v15 offset:5120
    ds_write_b128 v14, v[80:83] offset:0
    s_waitcnt vmcnt(2)
    v_mfma_f32_16x16x32_bf16 v[64:67], a[48:51], v[148:151], v[64:67]
    ds_read_b128 v[108:111], v15 offset:2048
    v_mfma_f32_16x16x32_bf16 v[68:71], a[52:55], v[148:151], v[68:71]
    ds_write_b128 v14, v[84:87] offset:1024
    v_mfma_f32_16x16x32_bf16 v[72:75], a[56:59], v[148:151], v[72:75]
    ds_read_b128 v[124:127], v15 offset:6144
    ds_read_b128 v[112:115], v15 offset:3072
    v_mfma_f32_16x16x32_bf16 v[76:79], a[60:63], v[148:151], v[76:79]
    ds_read_b128 v[128:131], v15 offset:7168
    s_waitcnt vmcnt(1)
    v_mfma_f32_16x16x32_bf16 v[64:67], a[80:83], v[152:155], v[64:67]
    s_waitcnt lgkmcnt(8)
    v_add_f32 v100, v100, v116
    v_add_f32 v101, v101, v117
    v_mfma_f32_16x16x32_bf16 v[68:71], a[84:87], v[152:155], v[68:71]
    v_add_f32 v102, v102, v118
    v_add_f32 v103, v103, v119
    ds_write_b128 v14, v[88:91] offset:2048
    v_mfma_f32_16x16x32_bf16 v[72:75], a[88:91], v[152:155], v[72:75]
    s_waitcnt lgkmcnt(7)
    v_add_f32 v104, v104, v120
    v_add_f32 v105, v105, v121
    v_mfma_f32_16x16x32_bf16 v[76:79], a[92:95], v[152:155], v[76:79]
    v_add_f32 v106, v106, v122
    v_add_f32 v107, v107, v123
    s_waitcnt vmcnt(0)
    v_mfma_f32_16x16x32_bf16 v[64:67], a[112:115], v[156:159], v[64:67]
    s_waitcnt lgkmcnt(3)
    v_add_f32 v108, v108, v124
    v_add_f32 v109, v109, v125
    v_mfma_f32_16x16x32_bf16 v[68:71], a[116:119], v[156:159], v[68:71]
    v_add_f32 v110, v110, v126
    v_add_f32 v111, v111, v127
    ds_write_b128 v14, v[92:95] offset:3072
    v_mfma_f32_16x16x32_bf16 v[72:75], a[120:123], v[156:159], v[72:75]
    s_waitcnt lgkmcnt(2)
    v_add_f32 v112, v112, v128
    v_add_f32 v113, v113, v129
    v_mfma_f32_16x16x32_bf16 v[76:79], a[124:127], v[156:159], v[76:79]
    v_add_f32 v114, v114, v130
    v_add_f32 v115, v115, v131
    s_waitcnt lgkmcnt(0)
    s_barrier
    ds_read_b128 v[116:119], v15 offset:8192
    ds_read_b128 v[120:123], v15 offset:9216
    ds_read_b128 v[124:127], v15 offset:10240
    ds_read_b128 v[128:131], v15 offset:11264
    v_pk_add_f32 v[64:65], v[64:65], v[100:101]
    v_pk_add_f32 v[66:67], v[66:67], v[102:103]
    v_pk_add_f32 v[68:69], v[68:69], v[104:105]
    v_pk_add_f32 v[70:71], v[70:71], v[106:107]
    v_pk_add_f32 v[72:73], v[72:73], v[108:109]
    v_pk_add_f32 v[74:75], v[74:75], v[110:111]
    v_pk_add_f32 v[76:77], v[76:77], v[112:113]
    v_pk_add_f32 v[78:79], v[78:79], v[114:115]
    s_waitcnt lgkmcnt(3)
    v_pk_add_f32 v[64:65], v[64:65], v[116:117]
    v_pk_add_f32 v[66:67], v[66:67], v[118:119]
    s_waitcnt lgkmcnt(2)
    v_pk_add_f32 v[68:69], v[68:69], v[120:121]
    v_pk_add_f32 v[70:71], v[70:71], v[122:123]
    s_waitcnt lgkmcnt(1)
    v_pk_add_f32 v[72:73], v[72:73], v[124:125]
    v_pk_add_f32 v[74:75], v[74:75], v[126:127]
    s_waitcnt lgkmcnt(0)
    v_pk_add_f32 v[76:77], v[76:77], v[128:129]
    v_pk_add_f32 v[78:79], v[78:79], v[130:131]
    v_cvt_pk_bf16_f32 v80, v64, v65
    v_cvt_pk_bf16_f32 v81, v66, v67
    v_cvt_pk_bf16_f32 v82, v68, v69
    v_cvt_pk_bf16_f32 v83, v70, v71
    buffer_store_dwordx4 v[80:83], v4, s[12:15], 0 offen sc1
    v_cvt_pk_bf16_f32 v84, v72, v73
    v_cvt_pk_bf16_f32 v85, v74, v75
    v_cvt_pk_bf16_f32 v86, v76, v77
    v_cvt_pk_bf16_f32 v87, v78, v79
    buffer_store_dwordx4 v[84:87], v4, s[12:15], 0 offen offset:64 sc1
    s_or_b32 s82, s40, s37
    s_cmp_lg_u32 s82, 0
    s_cbranch_scc1 L_exit
    s_mov_b64 exec, 1
    buffer_store_dword v30, off, s[4:7], 0 sc1
    s_mov_b64 exec, -1
L_exit:
    s_endpgm
L_pW_re:
    s_mov_b32 s82, 0
L_pW_lp:
    buffer_load_dword v185, v184, s[4:7], s93 offen sc1
    s_add_u32 s82, s82, 1
    s_cmp_gt_u32 s82, 400000
    s_cbranch_scc1 L_pW_ok
    s_waitcnt vmcnt(0)
    v_cmp_ne_u32 vcc, s28, v185
    s_cbranch_vccnz L_pW_lp
    s_branch L_pW_ok
L_pC10_re:
    s_mov_b32 s82, 0
L_pC10_lp:
    buffer_load_dword v240, v238, s[4:7], s76 offen offset:0 sc1
    s_add_u32 s82, s82, 1
    s_cmp_gt_u32 s82, 400000
    s_cbranch_scc1 L_pC10_ok
    s_waitcnt vmcnt(0)
    v_cmp_ne_u32 vcc, s28, v240
    s_cbranch_vccnz L_pC10_lp
    s_branch L_pC10_ok
L_pW2_re:
    s_mov_b32 s82, 0
L_pW2_lp:
    buffer_load_dword v197, v196, s[4:7], s2 offen sc1
    s_add_u32 s82, s82, 1
    s_cmp_gt_u32 s82, 400000
    s_cbranch_scc1 L_pW2_ok
    s_waitcnt vmcnt(0)
    v_cmp_ne_u32 vcc, s28, v197
    s_cbranch_vccnz L_pW2_lp
    s_branch L_pW2_ok
L_pA0_re:
    s_mov_b32 s82, 0
L_pA0_lp:
    buffer_load_dword v240, v239, s[4:7], s76 offen offset:4 sc1
    s_add_u32 s82, s82, 1
    s_cmp_gt_u32 s82, 400000
    s_cbranch_scc1 L_pA0_ok
    s_waitcnt vmcnt(0)
    v_cmp_ne_u32 vcc, s28, v240
    s_cbranch_vccnz L_pA0_lp
    s_branch L_pA0_ok
L_pR0_re:
    s_mov_b32 s82, 0
L_pR0_lp:
    buffer_load_dword v240, v239, s[4:7], s76 offen offset:8 sc1
    s_add_u32 s82, s82, 1
    s_cmp_gt_u32 s82, 400000
    s_cbranch_scc1 L_pR0_ok
    s_waitcnt vmcnt(0)
    v_cmp_ne_u32 vcc, s28, v240
    s_cbranch_vccnz L_pR0_lp
    s_branch L_pR0_ok
L_pB0_re:
    s_mov_b32 s82, 0
L_pB0_lp:
    buffer_load_dword v240, v239, s[4:7], s76 offen offset:12 sc1
    s_add_u32 s82, s82, 1
    s_cmp_gt_u32 s82, 400000
    s_cbranch_scc1 L_pB0_ok
    s_waitcnt vmcnt(0)
    v_cmp_ne_u32 vcc, s28, v240
    s_cbranch_vccnz L_pB0_lp
    s_branch L_pB0_ok
L_pC11_re:
    s_mov_b32 s82, 0
L_pC11_lp:
    buffer_load_dword v240, v238, s[4:7], s76 offen offset:0 sc1
    s_add_u32 s82, s82, 1
    s_cmp_gt_u32 s82, 400000
    s_cbranch_scc1 L_pC11_ok
    s_waitcnt vmcnt(0)
    v_cmp_ne_u32 vcc, s28, v240
    s_cbranch_vccnz L_pC11_lp
    s_branch L_pC11_ok
L_pA1_re:
    s_mov_b32 s82, 0
L_pA1_lp:
    buffer_load_dword v240, v239, s[4:7], s76 offen offset:4 sc1
    s_add_u32 s82, s82, 1
    s_cmp_gt_u32 s82, 400000
    s_cbranch_scc1 L_pA1_ok
    s_waitcnt vmcnt(0)
    v_cmp_ne_u32 vcc, s28, v240
    s_cbranch_vccnz L_pA1_lp
    s_branch L_pA1_ok
L_pR1_re:
    s_mov_b32 s82, 0
L_pR1_lp:
    buffer_load_dword v240, v239, s[4:7], s76 offen offset:8 sc1
    s_add_u32 s82, s82, 1
    s_cmp_gt_u32 s82, 400000
    s_cbranch_scc1 L_pR1_ok
    s_waitcnt vmcnt(0)
    v_cmp_ne_u32 vcc, s28, v240
    s_cbranch_vccnz L_pR1_lp
    s_branch L_pR1_ok
L_pB1_re:
    s_mov_b32 s82, 0
L_pB1_lp:
    buffer_load_dword v240, v239, s[4:7], s76 offen offset:12 sc1
    s_add_u32 s82, s82, 1
    s_cmp_gt_u32 s82, 400000
    s_cbranch_scc1 L_pB1_ok
    s_waitcnt vmcnt(0)
    v_cmp_ne_u32 vcc, s28, v240
    s_cbranch_vccnz L_pB1_lp
    s_branch L_pB1_ok
L_end:
    s_endpgm
.section .rodata,"a"
.p2align 6
.amdhsa_kernel interleave_layers__spectral_fnet__swiglu_ffn__prompt_kernel
  .amdhsa_next_free_vgpr 512
  .amdhsa_next_free_sgpr 102
  .amdhsa_accum_offset 256
  .amdhsa_group_segment_fixed_size 0
  .amdhsa_kernarg_size 96
  .amdhsa_user_sgpr_count 2
  .amdhsa_user_sgpr_kernarg_segment_ptr 1
  .amdhsa_system_sgpr_workgroup_id_x 1
  .amdhsa_float_denorm_mode_32 3
.end_amdhsa_kernel
```
